```python
import torch

def _softmax(x, axis=-1):
    return torch.softmax(x, dim=axis)

def _gelu(x):
    return torch.nn.functional.gelu(x, approximate='tanh')

def _silu(x):
    return torch.nn.functional.silu(x)

def _sigmoid(x):
    return torch.sigmoid(x)

def _layernorm(x, axis=-1, eps=1e-05):
    m = x.mean(dim=axis, keepdim=True)
    v = x.var(dim=axis, keepdim=True, unbiased=False)
    return (x - m) / torch.sqrt(v + eps)

def _scatter_add(tgt, idx, src, axis=0):
    return tgt.clone().index_add_(axis, idx, src)

def _segment_sum(src, seg, n):
    out = torch.zeros((n,) + src.shape[1:], dtype=src.dtype)
    return out.index_add_(0, seg, src)

def _pad(x, pw):
    flat = tuple((v for pair in reversed(pw) for v in pair))
    return torch.nn.functional.pad(x, flat)
kernel_name = 'standalone__kv_cache_quant_pre_rope_vs_post_rope__prompt'

def setup_inputs():

    _w = lambda a: (lambda t: t.to(torch.bfloat16) if t.is_floating_point() else t)(torch.as_tensor(a))
    B, Sq, Skv = (1, 2048, 2048)
    H, Dh0 = (8, 128)
    G = -1 if -1 > 0 else Dh0
    G = max(2, G // 2 * 2)
    Dh = max(G, Dh0 // G * G)
    Skv = max(Skv, Sq)
    ng = Dh // G
    bits = 2 if 2 > 1 else 4
    bits = max(2, min(8, bits))
    qmax = (1 << bits) - 1
    half = Dh // 2
    inv = 1.0 / 10000.0 ** (torch.arange(half) / max(1, half))
    ang_k = torch.arange(Skv)[:, None] * inv[None, :]
    ang_q = torch.arange(Skv - Sq, Skv)[:, None] * inv[None, :]
    kc = torch.cat([torch.cos(ang_k), torch.cos(ang_k)], dim=-1)
    ks = torch.cat([torch.sin(ang_k), torch.sin(ang_k)], dim=-1)
    qc = torch.cat([torch.cos(ang_q), torch.cos(ang_q)], dim=-1)
    qs = torch.cat([torch.sin(ang_q), torch.sin(ang_q)], dim=-1)
    qk_i = torch.randint(0, qmax + 1, (B, H, Skv, Dh)).to(torch.int32)
    qv_i = torch.randint(0, qmax + 1, (B, H, Skv, Dh)).to(torch.int32)
    ksc = torch.abs((lambda *s: torch.randn(*s, dtype=torch.bfloat16) * 0.4)(B, H, Skv, ng)) * 0.1 + 0.01
    kzp = torch.full((B, H, Skv, ng), qmax / 2.0)
    vsc = torch.abs((lambda *s: torch.randn(*s, dtype=torch.bfloat16) * 0.4)(B, H, Skv, ng)) * 0.1 + 0.01
    vzp = torch.full((B, H, Skv, ng), qmax / 2.0)
    return {'q': _w((lambda *s: torch.randn(*s, dtype=torch.bfloat16) * 6.4)(B, H, Sq, Dh) * 0.5), 'qk': _w(qk_i), 'k_scales': _w(ksc), 'k_zeros': _w(kzp), 'qv': _w(qv_i), 'v_scales': _w(vsc), 'v_zeros': _w(vzp), 'q_cos': _w(qc), 'q_sin': _w(qs), 'k_cos': _w(kc), 'k_sin': _w(ks)}

def reference(q, qk, k_scales, k_zeros, qv, v_scales, v_zeros, q_cos, q_sin, k_cos, k_sin):
    B, H, Sq, Dh = q.shape
    ng = k_scales.shape[-1]
    G = Dh // ng
    half = Dh // 2
    ks = (lambda x, n, axis: torch.repeat_interleave(x, n, dim=axis))(k_scales, G, axis=-1)
    kz = (lambda x, n, axis: torch.repeat_interleave(x, n, dim=axis))(k_zeros, G, axis=-1)
    k = ((lambda x, dt: x.to(dt))(qk, q.dtype) - kz) * ks
    vs = (lambda x, n, axis: torch.repeat_interleave(x, n, dim=axis))(v_scales, G, axis=-1)
    vz = (lambda x, n, axis: torch.repeat_interleave(x, n, dim=axis))(v_zeros, G, axis=-1)
    v = ((lambda x, dt: x.to(dt))(qv, q.dtype) - vz) * vs
    k1 = k[..., :half].clone()
    k2 = k[..., half:].clone()
    krh = torch.concatenate([-k2, k1], axis=-1)
    kr = k * k_cos[None, None, :, :] + krh * k_sin[None, None, :, :]
    q1 = q[..., :half].clone()
    q2 = q[..., half:].clone()
    qrh = torch.concatenate([-q2, q1], axis=-1)
    qr = q * q_cos[None, None, :, :] + qrh * q_sin[None, None, :, :]
    logits = torch.einsum('bhqd,bhkd->bhqk', qr, kr) * float(Dh) ** (-0.5)
    attn = _softmax(logits, axis=-1)
    out = torch.einsum('bhqk,bhkd->bhqd', attn, v)
    return out
```

```asm
; @launch grid=(256,1,1) block=(256,1,1) lds=148736
.amdgcn_target "amdgcn-amd-amdhsa--gfx950"
.text
.globl standalone__kv_cache_quant_pre_rope_vs_post_rope__prompt_kernel
.p2align 8
.type standalone__kv_cache_quant_pre_rope_vs_post_rope__prompt_kernel,@function
standalone__kv_cache_quant_pre_rope_vs_post_rope__prompt_kernel:
s_getpc_b64 s[66:67]
L_pc:
v_lshlrev_b32 v14, 7, v0
v_min_u32 v14, L_codeend-L_pc-4, v14
s_cmp_ge_u32 s2, 256
s_cbranch_scc1 L_end
global_load_dword v47, v14, s[66:67]
s_load_dwordx16 s[4:19], s[0:1], 0
s_load_dwordx8 s[20:27], s[0:1], 64
s_load_dwordx2 s[30:31], s[0:1], 104
v_lshrrev_b32 v1, 6, v0
v_and_b32 v5, 63, v0
s_and_b32 s32, s2, 4
s_bfe_u32 s36, s2, 0x20003
s_or_b32 s32, s32, s36
s_lshr_b32 s33, s2, 5
s_lshl_b32 s33, s33, 2
s_and_b32 s36, s2, 3
s_or_b32 s33, s33, s36
v_readfirstlane_b32 s34, v1
s_lshr_b32 s36, s2, 2
s_and_b32 s37, s34, 2
s_sub_u32 s37, s37, s36
s_and_b32 s37, s37, 3
s_and_b32 s38, s34, 1
s_lshl_b32 s38, s38, 2
s_add_u32 s37, s37, s38
s_lshl_b32 s29, s37, 20
s_xor_b32 s36, s34, 2
s_sub_u32 s36, s36, s32
s_and_b32 s36, s36, 3
s_lshr_b32 s37, s33, 1
s_lshl_b32 s37, s37, 2
s_add_u32 s65, s36, s37
v_lshrrev_b32 v8, 3, v5
v_and_b32 v9, 7, v5
v_lshlrev_b32 v33, 8, v8
v_lshl_add_u32 v33, v9, 4, v33
s_lshl_b32 s36, s2, 11
v_add_u32 v35, s36, v33
v_lshlrev_b32 v39, 1, v35
v_add_u32 v10, s29, v39
s_lshl_b32 s36, s32, 20
s_lshl_b32 s37, s65, 14
s_add_u32 s28, s36, s37
s_and_b32 s37, s33, 1
s_lshl_b32 s37, s37, 8
s_add_u32 s36, s28, s37
v_lshrrev_b32 v12, 4, v5
v_and_b32 v13, 15, v5
v_lshlrev_b32 v45, 11, v12
v_lshl_add_u32 v45, v13, 4, v45
v_add_u32 v45, s36, v45
v_add_u32 v46, 8192, v45
s_cmp_ge_u32 s34, 2
s_waitcnt lgkmcnt(0)
s_cbranch_scc1 L_r0v
global_load_dwordx4 v[16:19], v10, s[6:7] offset:0 nt
global_load_dwordx4 v[20:23], v10, s[6:7] offset:16 nt
global_load_dwordx4 v[24:27], v10, s[6:7] offset:256 nt
global_load_dwordx4 v[28:31], v10, s[6:7] offset:272 nt
global_load_dwordx4 v[48:51], v35, s[22:23] offset:0 nt
global_load_dwordx4 v[52:55], v35, s[22:23] offset:128 nt
global_load_dwordx4 v[56:59], v35, s[24:25] offset:0 nt
global_load_dwordx4 v[60:63], v35, s[24:25] offset:128 nt
s_branch L_r0d
L_r0v:
global_load_dwordx4 v[96:99], v45, s[12:13] offset:0 nt
global_load_dwordx4 v[100:103], v45, s[12:13] offset:512 nt
global_load_dwordx4 v[104:107], v45, s[12:13] offset:1024 nt
global_load_dwordx4 v[108:111], v45, s[12:13] offset:1536 nt
global_load_dwordx4 v[112:115], v46, s[12:13] offset:0 nt
global_load_dwordx4 v[116:119], v46, s[12:13] offset:512 nt
global_load_dwordx4 v[120:123], v46, s[12:13] offset:1024 nt
global_load_dwordx4 v[124:127], v46, s[12:13] offset:1536 nt
L_r0d:
s_lshl_b32 s36, s33, 14
s_lshl_b32 s37, s34, 12
s_add_u32 s36, s36, s37
s_lshl_b32 s37, s32, 19
v_add_u32 v33, s36, v33
v_add_u32 v32, s37, v33
s_add_u32 s38, s29, 0x100000
s_and_b32 s38, s38, 0x300000
s_and_b32 s1, s29, 0x400000
s_or_b32 s1, s1, s38
s_lshl_b32 s36, s2, 4
s_lshr_b32 s37, s29, 8
s_add_u32 s37, s37, s36
s_lshr_b32 s38, s1, 8
s_add_u32 s38, s38, s36
s_lshl_b32 s39, s32, 12
s_lshl_b32 s36, s65, 6
s_add_u32 s39, s39, s36
s_mov_b32 s36, 9437184
s_load_dword s35, s[30:31], s36
s_load_dwordx4 s[68:71], s[8:9], s37
s_load_dwordx4 s[72:75], s[10:11], s37
s_load_dwordx4 s[76:79], s[8:9], s38
s_load_dwordx4 s[80:83], s[10:11], s38
s_load_dwordx16 s[48:63], s[14:15], s39
s_load_dwordx16 s[84:99], s[16:17], s39
global_load_dwordx4 v[128:131], v32, s[4:5] offset:0 nt
global_load_dwordx4 v[132:135], v32, s[4:5] offset:128 nt
global_load_dwordx4 v[136:139], v33, s[18:19] offset:0
global_load_dwordx4 v[140:143], v33, s[18:19] offset:128
global_load_dwordx4 v[144:147], v33, s[20:21] offset:0
global_load_dwordx4 v[148:151], v33, s[20:21] offset:128
global_load_dwordx4 v[152:155], v32, s[4:5] offset:2048 nt
global_load_dwordx4 v[156:159], v32, s[4:5] offset:2176 nt
global_load_dwordx4 v[160:163], v33, s[18:19] offset:2048
v_lshlrev_b32 v1, 4, v5
v_add_u32 v2, 4096, v1
v_add_u32 v3, 8192, v1
v_add_u32 v4, 12288, v1
s_mul_i32 s0, s34, 2304
v_mul_u32_u24 v36, 144, v9
v_lshl_add_u32 v36, v8, 4, v36
v_add_u32 v36, s0, v36
v_mul_u32_u24 v37, 144, v8
v_lshl_add_u32 v37, v9, 4, v37
v_add_u32 v37, s0, v37
s_lshr_b32 s0, s2, 2
s_lshl_b32 s0, s0, 14
s_and_b32 s3, s2, 1
s_lshl_b32 s3, s3, 7
s_add_u32 s0, s0, s3
s_and_b32 s3, s2, 2
s_lshl_b32 s3, s3, 11
s_add_u32 s0, s0, s3
v_lshlrev_b32 v38, 9, v8
v_lshl_add_u32 v38, v9, 4, v38
v_add_u32 v38, s0, v38
s_and_b32 s0, s33, 1
s_lshl_b32 s0, s0, 12
s_add_u32 s0, s0, s28
v_add_u32 v44, s0, v3
s_mul_i32 s0, s34, 4160
s_add_u32 s0, s0, 25600
v_lshrrev_b32 v12, 1, v9
v_mul_u32_u24 v34, 1040, v12
v_and_b32 v12, 1, v9
v_lshl_add_u32 v34, v12, 9, v34
v_lshl_add_u32 v34, v8, 4, v34
v_add_u32 v34, s0, v34
v_lshrrev_b32 v12, 5, v5
v_bfe_u32 v13, v5, 3, 2
v_lshl_add_u32 v13, v13, 2, s34
v_subrev_u32 v14, s32, v12
v_and_b32 v14, 3, v14
v_lshl_add_u32 v14, v13, 2, v14
v_lshlrev_b32 v14, 2, v14
v_add_u32 v14, v9, v14
s_lshl_b32 s0, s32, 8
v_add_u32 v14, s0, v14
v_lshlrev_b32 v14, 6, v14
v_add_u32 v14, 8388608, v14
v_and_b32 v15, 1, v9
v_lshl_add_u32 v15, v13, 1, v15
v_lshl_add_u32 v15, v15, 2, v12
s_lshl_b32 s0, s32, 7
v_add_u32 v15, s0, v15
v_lshlrev_b32 v15, 6, v15
v_add_u32 v15, 8912896, v15
v_cmp_gt_u32 vcc, 4, v9
s_nop 1
v_cndmask_b32 v6, v15, v14, vcc
v_add_u32 v11, s1, v39
s_cmp_lt_u32 s34, 2
s_cselect_b32 s0, s1, s29
v_add_u32 v10, s0, v39
s_mov_b32 s46, 0x3e0293ee
s_mov_b32 s47, 0x3e0293ee
s_mov_b32 s45, 0x44800000
s_mov_b32 s40, s30
s_mov_b32 s41, s31
s_mov_b32 s42, 0x800000
s_mov_b32 s43, 0x20000
v_and_b32 v12, 1, v8
v_lshlrev_b32 v12, 4, v12
s_waitcnt lgkmcnt(0)
v_mov_b32 v40, s68
v_mov_b32 v41, s72
v_mov_b32 v42, s76
v_mov_b32 v43, s80
v_mov_b32 v176, s48
v_mov_b32 v177, s49
v_mov_b32 v178, s56
v_mov_b32 v179, s57
v_mov_b32 v180, s84
v_mov_b32 v181, s85
v_mov_b32 v182, s92
v_mov_b32 v183, s93
s_lshl_b64 exec, -1, 16
v_mov_b32 v40, s69
v_mov_b32 v41, s73
v_mov_b32 v42, s77
v_mov_b32 v43, s81
v_mov_b32 v176, s50
v_mov_b32 v177, s51
v_mov_b32 v178, s58
v_mov_b32 v179, s59
v_mov_b32 v180, s86
v_mov_b32 v181, s87
v_mov_b32 v182, s94
v_mov_b32 v183, s95
s_lshl_b64 exec, -1, 32
v_mov_b32 v40, s70
v_mov_b32 v41, s74
v_mov_b32 v42, s78
v_mov_b32 v43, s82
v_mov_b32 v176, s52
v_mov_b32 v177, s53
v_mov_b32 v178, s60
v_mov_b32 v179, s61
v_mov_b32 v180, s88
v_mov_b32 v181, s89
v_mov_b32 v182, s96
v_mov_b32 v183, s97
s_lshl_b64 exec, -1, 48
v_mov_b32 v40, s71
v_mov_b32 v41, s75
v_mov_b32 v42, s79
v_mov_b32 v43, s83
v_mov_b32 v176, s54
v_mov_b32 v177, s55
v_mov_b32 v178, s62
v_mov_b32 v179, s63
v_mov_b32 v180, s90
v_mov_b32 v181, s91
v_mov_b32 v182, s98
v_mov_b32 v183, s99
s_mov_b64 exec, -1
v_lshrrev_b32 v40, v12, v40
v_lshlrev_b32 v40, 16, v40
v_lshrrev_b32 v41, v12, v41
v_lshlrev_b32 v41, 16, v41
v_lshrrev_b32 v42, v12, v42
v_lshlrev_b32 v42, 16, v42
v_lshrrev_b32 v43, v12, v43
v_lshlrev_b32 v43, 16, v43
v_mul_f32 v41, v41, v40
v_mul_f32 v43, v43, v42
v_lshlrev_b32 v64, 16, v176
v_and_b32 v65, 0xffff0000, v176
v_lshlrev_b32 v72, 16, v180
v_and_b32 v73, 0xffff0000, v180
v_lshlrev_b32 v66, 16, v177
v_and_b32 v67, 0xffff0000, v177
v_lshlrev_b32 v74, 16, v181
v_and_b32 v75, 0xffff0000, v181
v_lshlrev_b32 v68, 16, v178
v_and_b32 v69, 0xffff0000, v178
v_lshlrev_b32 v76, 16, v182
v_and_b32 v77, 0xffff0000, v182
v_lshlrev_b32 v70, 16, v179
v_and_b32 v71, 0xffff0000, v179
v_lshlrev_b32 v78, 16, v183
v_and_b32 v79, 0xffff0000, v183
v_pk_mul_f32 v[72:73], v[72:73], v[64:65]
v_pk_mul_f32 v[74:75], v[74:75], v[66:67]
v_pk_mul_f32 v[76:77], v[76:77], v[68:69]
v_pk_mul_f32 v[78:79], v[78:79], v[70:71]
s_lshl_b32 s36, s32, 20
s_lshl_b32 s37, s34, 16
s_add_u32 s36, s36, s37
s_lshr_b32 s38, s33, 2
s_add_u32 s37, s38, 0
s_and_b32 s37, s37, 3
s_lshl_b32 s37, s37, 18
s_add_u32 s60, s37, s36
s_add_u32 s37, s38, 1
s_and_b32 s37, s37, 3
s_lshl_b32 s37, s37, 18
s_add_u32 s61, s37, s36
s_add_u32 s37, s38, 2
s_and_b32 s37, s37, 3
s_lshl_b32 s37, s37, 18
s_add_u32 s62, s37, s36
s_add_u32 s37, s38, 3
s_and_b32 s37, s37, 3
s_lshl_b32 s37, s37, 18
s_add_u32 s63, s37, s36
s_sub_u32 s37, 0, s32
s_and_b32 s37, s37, 3
s_lshl_b32 s37, s37, 14
s_add_u32 s48, s60, s37
s_add_u32 s49, s61, s37
s_add_u32 s50, s62, s37
s_add_u32 s51, s63, s37
s_sub_u32 s37, 1, s32
s_and_b32 s37, s37, 3
s_lshl_b32 s37, s37, 14
s_add_u32 s52, s60, s37
s_add_u32 s53, s61, s37
s_add_u32 s54, s62, s37
s_add_u32 s55, s63, s37
s_sub_u32 s37, 2, s32
s_and_b32 s37, s37, 3
s_lshl_b32 s37, s37, 14
s_add_u32 s56, s60, s37
s_add_u32 s57, s61, s37
s_add_u32 s58, s62, s37
s_add_u32 s59, s63, s37
s_sub_u32 s37, 3, s32
s_and_b32 s37, s37, 3
s_lshl_b32 s37, s37, 14
s_add_u32 s60, s60, s37
s_add_u32 s61, s61, s37
s_add_u32 s62, s62, s37
s_add_u32 s63, s63, s37
s_mov_b32 s64, 0x1000000
s_mov_b32 s44, s48
s_add_u32 s35, s35, 0x9e3779b9
s_and_b32 s0, s34, 1
s_lshl_b32 s0, s0, 13
v_add_u32 v35, s0, v1
s_waitcnt vmcnt(9)
s_cmp_ge_u32 s34, 2
s_cbranch_scc1 L_t0v
v_lshlrev_b32 v192, 16, v48
v_and_b32 v193, 0xffff0000, v48
v_lshlrev_b32 v194, 16, v52
v_and_b32 v195, 0xffff0000, v52
v_lshlrev_b32 v196, 16, v56
v_and_b32 v197, 0xffff0000, v56
v_lshlrev_b32 v198, 16, v60
v_and_b32 v199, 0xffff0000, v60
v_lshlrev_b32 v200, 16, v49
v_and_b32 v201, 0xffff0000, v49
v_lshlrev_b32 v202, 16, v53
v_and_b32 v203, 0xffff0000, v53
v_lshlrev_b32 v204, 16, v57
v_and_b32 v205, 0xffff0000, v57
v_lshlrev_b32 v206, 16, v61
v_and_b32 v207, 0xffff0000, v61
v_lshlrev_b32 v208, 16, v50
v_and_b32 v209, 0xffff0000, v50
v_lshlrev_b32 v210, 16, v54
v_and_b32 v211, 0xffff0000, v54
v_lshlrev_b32 v212, 16, v58
v_and_b32 v213, 0xffff0000, v58
v_lshlrev_b32 v214, 16, v62
v_and_b32 v215, 0xffff0000, v62
v_lshlrev_b32 v216, 16, v51
v_and_b32 v217, 0xffff0000, v51
v_lshlrev_b32 v218, 16, v55
v_and_b32 v219, 0xffff0000, v55
v_lshlrev_b32 v220, 16, v59
v_and_b32 v221, 0xffff0000, v59
v_lshlrev_b32 v222, 16, v63
v_and_b32 v223, 0xffff0000, v63
s_call_b64 s[66:67], L_ktask0
ds_write_b128 v35, v[192:195] offset:9216
ds_write_b128 v35, v[196:199] offset:10240
ds_write_b128 v35, v[200:203] offset:11264
ds_write_b128 v35, v[204:207] offset:12288
ds_write_b128 v35, v[208:211] offset:13312
ds_write_b128 v35, v[212:215] offset:14336
ds_write_b128 v35, v[216:219] offset:15360
ds_write_b128 v35, v[220:223] offset:16384
s_waitcnt lgkmcnt(0)
s_branch L_t0d
L_t0v:
s_call_b64 s[66:67], L_vtask
L_t0d:
s_barrier
global_load_dwordx4 v[164:167], v33, s[18:19] offset:2176
global_load_dwordx4 v[168:171], v33, s[20:21] offset:2048
global_load_dwordx4 v[172:175], v33, s[20:21] offset:2176
global_load_dwordx4 v[16:19], v10, s[6:7] offset:0 nt
global_load_dwordx4 v[20:23], v10, s[6:7] offset:16 nt
global_load_dwordx4 v[24:27], v10, s[6:7] offset:256 nt
global_load_dwordx4 v[28:31], v10, s[6:7] offset:272 nt
ds_read_b128 v[192:195], v35 offset:9216
ds_read_b128 v[196:199], v35 offset:10240
ds_read_b128 v[200:203], v35 offset:11264
ds_read_b128 v[204:207], v35 offset:12288
ds_read_b128 v[208:211], v35 offset:13312
ds_read_b128 v[212:215], v35 offset:14336
ds_read_b128 v[216:219], v35 offset:15360
ds_read_b128 v[220:223], v35 offset:16384
v_accvgpr_write_b32 a64, 0
v_accvgpr_write_b32 a65, 0
v_accvgpr_write_b32 a66, 0
v_accvgpr_write_b32 a67, 0
v_accvgpr_write_b32 a68, 0
v_accvgpr_write_b32 a69, 0
v_accvgpr_write_b32 a70, 0
v_accvgpr_write_b32 a71, 0
v_accvgpr_write_b32 a72, 0
v_accvgpr_write_b32 a73, 0
v_accvgpr_write_b32 a74, 0
v_accvgpr_write_b32 a75, 0
v_accvgpr_write_b32 a76, 0
v_accvgpr_write_b32 a77, 0
v_accvgpr_write_b32 a78, 0
v_accvgpr_write_b32 a79, 0
v_accvgpr_write_b32 a80, 0
v_accvgpr_write_b32 a81, 0
v_accvgpr_write_b32 a82, 0
v_accvgpr_write_b32 a83, 0
v_accvgpr_write_b32 a84, 0
v_accvgpr_write_b32 a85, 0
v_accvgpr_write_b32 a86, 0
v_accvgpr_write_b32 a87, 0
v_accvgpr_write_b32 a88, 0
v_accvgpr_write_b32 a89, 0
v_accvgpr_write_b32 a90, 0
v_accvgpr_write_b32 a91, 0
v_accvgpr_write_b32 a92, 0
v_accvgpr_write_b32 a93, 0
v_accvgpr_write_b32 a94, 0
v_accvgpr_write_b32 a95, 0
v_accvgpr_write_b32 a96, 0
v_accvgpr_write_b32 a97, 0
v_accvgpr_write_b32 a98, 0
v_accvgpr_write_b32 a99, 0
v_accvgpr_write_b32 a100, 0
v_accvgpr_write_b32 a101, 0
v_accvgpr_write_b32 a102, 0
v_accvgpr_write_b32 a103, 0
v_accvgpr_write_b32 a104, 0
v_accvgpr_write_b32 a105, 0
v_accvgpr_write_b32 a106, 0
v_accvgpr_write_b32 a107, 0
v_accvgpr_write_b32 a108, 0
v_accvgpr_write_b32 a109, 0
v_accvgpr_write_b32 a110, 0
v_accvgpr_write_b32 a111, 0
v_accvgpr_write_b32 a112, 0
v_accvgpr_write_b32 a113, 0
v_accvgpr_write_b32 a114, 0
v_accvgpr_write_b32 a115, 0
v_accvgpr_write_b32 a116, 0
v_accvgpr_write_b32 a117, 0
v_accvgpr_write_b32 a118, 0
v_accvgpr_write_b32 a119, 0
v_accvgpr_write_b32 a120, 0
v_accvgpr_write_b32 a121, 0
v_accvgpr_write_b32 a122, 0
v_accvgpr_write_b32 a123, 0
v_accvgpr_write_b32 a124, 0
v_accvgpr_write_b32 a125, 0
v_accvgpr_write_b32 a126, 0
v_accvgpr_write_b32 a127, 0
s_waitcnt vmcnt(7)
v_mov_b32 v15, s35
s_mov_b64 exec, 1
global_store_dword v0, v15, s[30:31] sc1
s_mov_b64 exec, -1
s_waitcnt vmcnt(15)
s_cmp_ge_u32 s34, 2
s_cbranch_scc1 L_w_1
s_waitcnt vmcnt(13)
L_w_1:
v_lshlrev_b32 v224, 16, v136
v_and_b32 v225, 0xffff0000, v136
v_lshlrev_b32 v226, 16, v140
v_and_b32 v227, 0xffff0000, v140
v_lshlrev_b32 v228, 16, v144
v_and_b32 v229, 0xffff0000, v144
v_lshlrev_b32 v230, 16, v148
v_and_b32 v231, 0xffff0000, v148
v_lshlrev_b32 v232, 16, v137
v_and_b32 v233, 0xffff0000, v137
v_lshlrev_b32 v234, 16, v141
v_and_b32 v235, 0xffff0000, v141
v_lshlrev_b32 v236, 16, v145
v_and_b32 v237, 0xffff0000, v145
v_lshlrev_b32 v238, 16, v149
v_and_b32 v239, 0xffff0000, v149
v_lshlrev_b32 v240, 16, v138
v_and_b32 v241, 0xffff0000, v138
v_lshlrev_b32 v242, 16, v142
v_and_b32 v243, 0xffff0000, v142
v_lshlrev_b32 v244, 16, v146
v_and_b32 v245, 0xffff0000, v146
v_lshlrev_b32 v246, 16, v150
v_and_b32 v247, 0xffff0000, v150
v_lshlrev_b32 v248, 16, v139
v_and_b32 v249, 0xffff0000, v139
v_lshlrev_b32 v250, 16, v143
v_and_b32 v251, 0xffff0000, v143
v_lshlrev_b32 v252, 16, v147
v_and_b32 v253, 0xffff0000, v147
v_lshlrev_b32 v254, 16, v151
v_and_b32 v255, 0xffff0000, v151
v_lshlrev_b32 v48, 16, v128
v_and_b32 v49, 0xffff0000, v128
v_lshlrev_b32 v56, 16, v132
v_and_b32 v57, 0xffff0000, v132
v_lshlrev_b32 v50, 16, v129
v_and_b32 v51, 0xffff0000, v129
v_lshlrev_b32 v58, 16, v133
v_and_b32 v59, 0xffff0000, v133
v_lshlrev_b32 v52, 16, v130
v_and_b32 v53, 0xffff0000, v130
v_lshlrev_b32 v60, 16, v134
v_and_b32 v61, 0xffff0000, v134
v_lshlrev_b32 v54, 16, v131
v_and_b32 v55, 0xffff0000, v131
v_lshlrev_b32 v62, 16, v135
v_and_b32 v63, 0xffff0000, v135
v_pk_mul_f32 v[48:49], v[48:49], s[46:47]
v_pk_mul_f32 v[50:51], v[50:51], s[46:47]
v_pk_mul_f32 v[52:53], v[52:53], s[46:47]
v_pk_mul_f32 v[54:55], v[54:55], s[46:47]
v_pk_mul_f32 v[56:57], v[56:57], s[46:47]
v_pk_mul_f32 v[58:59], v[58:59], s[46:47]
v_pk_mul_f32 v[60:61], v[60:61], s[46:47]
v_pk_mul_f32 v[62:63], v[62:63], s[46:47]
v_pk_mul_f32 v[12:13], v[48:49], v[224:225]
v_pk_mul_f32 v[14:15], v[56:57], v[226:227]
v_pk_fma_f32 v[12:13], v[56:57], v[228:229], v[12:13] neg_lo:[1,0,0] neg_hi:[1,0,0]
v_pk_fma_f32 v[14:15], v[48:49], v[230:231], v[14:15]
v_cvt_pk_bf16_f32 v128, v12, v13
v_cvt_pk_bf16_f32 v132, v14, v15
v_pk_mul_f32 v[12:13], v[50:51], v[232:233]
v_pk_mul_f32 v[14:15], v[58:59], v[234:235]
v_pk_fma_f32 v[12:13], v[58:59], v[236:237], v[12:13] neg_lo:[1,0,0] neg_hi:[1,0,0]
v_pk_fma_f32 v[14:15], v[50:51], v[238:239], v[14:15]
v_cvt_pk_bf16_f32 v129, v12, v13
v_cvt_pk_bf16_f32 v133, v14, v15
v_pk_mul_f32 v[12:13], v[52:53], v[240:241]
v_pk_mul_f32 v[14:15], v[60:61], v[242:243]
v_pk_fma_f32 v[12:13], v[60:61], v[244:245], v[12:13] neg_lo:[1,0,0] neg_hi:[1,0,0]
v_pk_fma_f32 v[14:15], v[52:53], v[246:247], v[14:15]
v_cvt_pk_bf16_f32 v130, v12, v13
v_cvt_pk_bf16_f32 v134, v14, v15
v_pk_mul_f32 v[12:13], v[54:55], v[248:249]
v_pk_mul_f32 v[14:15], v[62:63], v[250:251]
v_pk_fma_f32 v[12:13], v[62:63], v[252:253], v[12:13] neg_lo:[1,0,0] neg_hi:[1,0,0]
v_pk_fma_f32 v[14:15], v[54:55], v[254:255], v[14:15]
v_cvt_pk_bf16_f32 v131, v12, v13
v_cvt_pk_bf16_f32 v135, v14, v15
ds_write_b128 v34, v[128:131] offset:0
ds_write_b128 v34, v[132:135] offset:256
s_cmp_ge_u32 s34, 2
s_cbranch_scc1 L_r2k
global_load_dwordx4 v[96:99], v45, s[12:13] offset:0 nt
global_load_dwordx4 v[100:103], v45, s[12:13] offset:512 nt
global_load_dwordx4 v[104:107], v45, s[12:13] offset:1024 nt
global_load_dwordx4 v[108:111], v45, s[12:13] offset:1536 nt
global_load_dwordx4 v[112:115], v46, s[12:13] offset:0 nt
global_load_dwordx4 v[116:119], v46, s[12:13] offset:512 nt
global_load_dwordx4 v[120:123], v46, s[12:13] offset:1024 nt
global_load_dwordx4 v[124:127], v46, s[12:13] offset:1536 nt
s_branch L_r2d
L_r2k:
global_load_dwordx4 v[80:83], v11, s[6:7] offset:0 nt
global_load_dwordx4 v[84:87], v11, s[6:7] offset:16 nt
global_load_dwordx4 v[88:91], v11, s[6:7] offset:256 nt
global_load_dwordx4 v[92:95], v11, s[6:7] offset:272 nt
L_r2d:
s_waitcnt vmcnt(13)
s_cmp_lt_u32 s34, 2
s_cbranch_scc1 L_w_2
s_waitcnt vmcnt(9)
L_w_2:
v_lshlrev_b32 v224, 16, v160
v_and_b32 v225, 0xffff0000, v160
v_lshlrev_b32 v226, 16, v164
v_and_b32 v227, 0xffff0000, v164
v_lshlrev_b32 v228, 16, v168
v_and_b32 v229, 0xffff0000, v168
v_lshlrev_b32 v230, 16, v172
v_and_b32 v231, 0xffff0000, v172
v_lshlrev_b32 v232, 16, v161
v_and_b32 v233, 0xffff0000, v161
v_lshlrev_b32 v234, 16, v165
v_and_b32 v235, 0xffff0000, v165
v_lshlrev_b32 v236, 16, v169
v_and_b32 v237, 0xffff0000, v169
v_lshlrev_b32 v238, 16, v173
v_and_b32 v239, 0xffff0000, v173
v_lshlrev_b32 v240, 16, v162
v_and_b32 v241, 0xffff0000, v162
v_lshlrev_b32 v242, 16, v166
v_and_b32 v243, 0xffff0000, v166
v_lshlrev_b32 v244, 16, v170
v_and_b32 v245, 0xffff0000, v170
v_lshlrev_b32 v246, 16, v174
v_and_b32 v247, 0xffff0000, v174
v_lshlrev_b32 v248, 16, v163
v_and_b32 v249, 0xffff0000, v163
v_lshlrev_b32 v250, 16, v167
v_and_b32 v251, 0xffff0000, v167
v_lshlrev_b32 v252, 16, v171
v_and_b32 v253, 0xffff0000, v171
v_lshlrev_b32 v254, 16, v175
v_and_b32 v255, 0xffff0000, v175
v_lshlrev_b32 v48, 16, v152
v_and_b32 v49, 0xffff0000, v152
v_lshlrev_b32 v56, 16, v156
v_and_b32 v57, 0xffff0000, v156
v_lshlrev_b32 v50, 16, v153
v_and_b32 v51, 0xffff0000, v153
v_lshlrev_b32 v58, 16, v157
v_and_b32 v59, 0xffff0000, v157
v_lshlrev_b32 v52, 16, v154
v_and_b32 v53, 0xffff0000, v154
v_lshlrev_b32 v60, 16, v158
v_and_b32 v61, 0xffff0000, v158
v_lshlrev_b32 v54, 16, v155
v_and_b32 v55, 0xffff0000, v155
v_lshlrev_b32 v62, 16, v159
v_and_b32 v63, 0xffff0000, v159
v_pk_mul_f32 v[48:49], v[48:49], s[46:47]
v_pk_mul_f32 v[50:51], v[50:51], s[46:47]
v_pk_mul_f32 v[52:53], v[52:53], s[46:47]
v_pk_mul_f32 v[54:55], v[54:55], s[46:47]
v_pk_mul_f32 v[56:57], v[56:57], s[46:47]
v_pk_mul_f32 v[58:59], v[58:59], s[46:47]
v_pk_mul_f32 v[60:61], v[60:61], s[46:47]
v_pk_mul_f32 v[62:63], v[62:63], s[46:47]
v_pk_mul_f32 v[12:13], v[48:49], v[224:225]
v_pk_mul_f32 v[14:15], v[56:57], v[226:227]
v_pk_fma_f32 v[12:13], v[56:57], v[228:229], v[12:13] neg_lo:[1,0,0] neg_hi:[1,0,0]
v_pk_fma_f32 v[14:15], v[48:49], v[230:231], v[14:15]
v_cvt_pk_bf16_f32 v152, v12, v13
v_cvt_pk_bf16_f32 v156, v14, v15
v_pk_mul_f32 v[12:13], v[50:51], v[232:233]
v_pk_mul_f32 v[14:15], v[58:59], v[234:235]
v_pk_fma_f32 v[12:13], v[58:59], v[236:237], v[12:13] neg_lo:[1,0,0] neg_hi:[1,0,0]
v_pk_fma_f32 v[14:15], v[50:51], v[238:239], v[14:15]
v_cvt_pk_bf16_f32 v153, v12, v13
v_cvt_pk_bf16_f32 v157, v14, v15
v_pk_mul_f32 v[12:13], v[52:53], v[240:241]
v_pk_mul_f32 v[14:15], v[60:61], v[242:243]
v_pk_fma_f32 v[12:13], v[60:61], v[244:245], v[12:13] neg_lo:[1,0,0] neg_hi:[1,0,0]
v_pk_fma_f32 v[14:15], v[52:53], v[246:247], v[14:15]
v_cvt_pk_bf16_f32 v154, v12, v13
v_cvt_pk_bf16_f32 v158, v14, v15
v_pk_mul_f32 v[12:13], v[54:55], v[248:249]
v_pk_mul_f32 v[14:15], v[62:63], v[250:251]
v_pk_fma_f32 v[12:13], v[62:63], v[252:253], v[12:13] neg_lo:[1,0,0] neg_hi:[1,0,0]
v_pk_fma_f32 v[14:15], v[54:55], v[254:255], v[14:15]
v_cvt_pk_bf16_f32 v155, v12, v13
v_cvt_pk_bf16_f32 v159, v14, v15
ds_write_b128 v34, v[152:155] offset:128
ds_write_b128 v34, v[156:159] offset:384
s_waitcnt vmcnt(9) lgkmcnt(0)
s_cmp_lt_u32 s34, 2
s_cbranch_scc1 L_w_3
s_waitcnt vmcnt(5)
L_w_3:
s_cmp_ge_u32 s34, 2
s_cbranch_scc1 L_role_4
s_call_b64 s[66:67], L_ktask1
s_branch L_roled_5
L_role_4:
s_call_b64 s[66:67], L_ktask0
L_roled_5:
global_load_dword v32, v6, s[30:31] sc1
s_barrier
ds_read_b128 a[128:131], v1 offset:25600
ds_read_b128 a[132:135], v1 offset:26640
ds_read_b128 a[136:139], v1 offset:27680
ds_read_b128 a[140:143], v1 offset:28720
ds_read_b128 a[144:147], v1 offset:29760
ds_read_b128 a[148:151], v1 offset:30800
ds_read_b128 a[152:155], v1 offset:31840
ds_read_b128 a[156:159], v1 offset:32880
ds_read_b128 a[160:163], v1 offset:33920
ds_read_b128 a[164:167], v1 offset:34960
ds_read_b128 a[168:171], v1 offset:36000
ds_read_b128 a[172:175], v1 offset:37040
ds_read_b128 a[176:179], v1 offset:38080
ds_read_b128 a[180:183], v1 offset:39120
ds_read_b128 a[184:187], v1 offset:40160
ds_read_b128 a[188:191], v1 offset:41200
s_waitcnt vmcnt(0)
v_mov_b32 v15, s35
s_mov_b64 exec, 1
global_store_dword v0, v15, s[30:31] sc1
s_mov_b64 exec, -1
v_cmp_ne_u32 vcc, s35, v32
s_mov_b32 s28, vcc_lo
s_cmp_lg_u32 vcc_lo, 0
s_cbranch_scc1 L_nok0
buffer_load_dwordx4 v[128:131], v1, s[40:43], s44 offen offset:0 sc1
buffer_load_dwordx4 v[132:135], v1, s[40:43], s44 offen offset:1024 sc1
buffer_load_dwordx4 v[136:139], v1, s[40:43], s44 offen offset:2048 sc1
buffer_load_dwordx4 v[140:143], v1, s[40:43], s44 offen offset:3072 sc1
buffer_load_dwordx4 v[144:147], v2, s[40:43], s44 offen offset:0 sc1
buffer_load_dwordx4 v[148:151], v2, s[40:43], s44 offen offset:1024 sc1
buffer_load_dwordx4 v[152:155], v2, s[40:43], s44 offen offset:2048 sc1
buffer_load_dwordx4 v[156:159], v2, s[40:43], s44 offen offset:3072 sc1
s_branch L_r2go
L_nok0:
global_load_dword v32, v6, s[30:31] sc1
L_r2go:
s_cmp_ge_u32 s34, 2
s_cbranch_scc1 L_role_6
s_call_b64 s[66:67], L_vtask
s_branch L_roled_7
L_role_6:
s_call_b64 s[66:67], L_ktask1b
L_roled_7:
s_cmp_eq_u32 s28, 0
s_cbranch_scc1 L_havek
s_mov_b32 s3, 0
s_waitcnt vmcnt(2)
s_branch L_p0c
L_p0:
global_load_dword v32, v6, s[30:31] sc1
s_waitcnt vmcnt(0)
L_p0c:
v_cmp_ne_u32 vcc, s35, v32
s_cmp_eq_u32 vcc_lo, 0
s_cbranch_scc1 L_p0d
s_sleep 1
s_add_u32 s3, s3, 1
s_cmp_lt_u32 s3, 0x8000
s_cbranch_scc1 L_p0
L_p0d:
buffer_load_dwordx4 v[128:131], v1, s[40:43], s44 offen offset:0 sc1
buffer_load_dwordx4 v[132:135], v1, s[40:43], s44 offen offset:1024 sc1
buffer_load_dwordx4 v[136:139], v1, s[40:43], s44 offen offset:2048 sc1
buffer_load_dwordx4 v[140:143], v1, s[40:43], s44 offen offset:3072 sc1
buffer_load_dwordx4 v[144:147], v2, s[40:43], s44 offen offset:0 sc1
buffer_load_dwordx4 v[148:151], v2, s[40:43], s44 offen offset:1024 sc1
buffer_load_dwordx4 v[152:155], v2, s[40:43], s44 offen offset:2048 sc1
buffer_load_dwordx4 v[156:159], v2, s[40:43], s44 offen offset:3072 sc1
L_havek:
v_mov_b32 v64, 0
v_mov_b32 v65, 0
v_mov_b32 v66, 0
v_mov_b32 v67, 0
buffer_load_dwordx4 v[192:195], v3, s[40:43], s44 offen offset:0 sc1
buffer_load_dwordx4 v[196:199], v3, s[40:43], s44 offen offset:1024 sc1
buffer_load_dwordx4 v[200:203], v3, s[40:43], s44 offen offset:2048 sc1
buffer_load_dwordx4 v[204:207], v3, s[40:43], s44 offen offset:3072 sc1
s_waitcnt vmcnt(8) lgkmcnt(0)
s_cmp_lt_u32 s34, 2
s_cbranch_scc1 L_w_8
s_waitcnt vmcnt(6)
L_w_8:
s_cmp_eq_u32 s28, 0
s_cbranch_scc1 L_k0ok
s_waitcnt vmcnt(4)
L_k0ok:
v_mfma_f32_16x16x32_bf16 v[16:19], v[128:131], a[128:131], 0
v_mfma_f32_16x16x32_bf16 v[16:19], v[132:135], a[132:135], v[16:19]
buffer_load_dwordx4 v[208:211], v4, s[40:43], s44 offen offset:0 sc1
v_mfma_f32_16x16x32_bf16 v[16:19], v[136:139], a[136:139], v[16:19]
v_mfma_f32_16x16x32_bf16 v[16:19], v[140:143], a[140:143], v[16:19]
buffer_load_dwordx4 v[212:215], v4, s[40:43], s44 offen offset:1024 sc1
v_mfma_f32_16x16x32_bf16 v[20:23], v[144:147], a[128:131], 0
v_mfma_f32_16x16x32_bf16 v[20:23], v[148:151], a[132:135], v[20:23]
buffer_load_dwordx4 v[216:219], v4, s[40:43], s44 offen offset:2048 sc1
v_mfma_f32_16x16x32_bf16 v[20:23], v[152:155], a[136:139], v[20:23]
v_mfma_f32_16x16x32_bf16 v[20:23], v[156:159], a[140:143], v[20:23]
buffer_load_dwordx4 v[220:223], v4, s[40:43], s44 offen offset:3072 sc1
v_mfma_f32_16x16x32_bf16 v[24:27], v[128:131], a[144:147], 0
v_mfma_f32_16x16x32_bf16 v[24:27], v[132:135], a[148:151], v[24:27]
s_mov_b32 s44, s49
buffer_load_dwordx4 v[160:163], v1, s[40:43], s44 offen offset:0 sc1
v_mfma_f32_16x16x32_bf16 v[24:27], v[136:139], a[152:155], v[24:27]
v_mfma_f32_16x16x32_bf16 v[24:27], v[140:143], a[156:159], v[24:27]
buffer_load_dwordx4 v[164:167], v1, s[40:43], s44 offen offset:1024 sc1
v_mfma_f32_16x16x32_bf16 v[28:31], v[144:147], a[144:147], 0
v_mfma_f32_16x16x32_bf16 v[28:31], v[148:151], a[148:151], v[28:31]
buffer_load_dwordx4 v[168:171], v1, s[40:43], s44 offen offset:2048 sc1
v_mfma_f32_16x16x32_bf16 v[28:31], v[152:155], a[152:155], v[28:31]
v_mfma_f32_16x16x32_bf16 v[28:31], v[156:159], a[156:159], v[28:31]
buffer_load_dwordx4 v[172:175], v1, s[40:43], s44 offen offset:3072 sc1
v_mfma_f32_16x16x32_bf16 v[32:35], v[128:131], a[160:163], 0
v_mfma_f32_16x16x32_bf16 v[32:35], v[132:135], a[164:167], v[32:35]
buffer_load_dwordx4 v[176:179], v2, s[40:43], s44 offen offset:0 sc1
v_mfma_f32_16x16x32_bf16 v[32:35], v[136:139], a[168:171], v[32:35]
v_mfma_f32_16x16x32_bf16 v[32:35], v[140:143], a[172:175], v[32:35]
buffer_load_dwordx4 v[180:183], v2, s[40:43], s44 offen offset:1024 sc1
v_mfma_f32_16x16x32_bf16 v[36:39], v[144:147], a[160:163], 0
v_max3_f32 v8, v16, v17, v18
v_max3_f32 v9, v24, v25, v26
v_mfma_f32_16x16x32_bf16 v[36:39], v[148:151], a[164:167], v[36:39]
v_max3_f32 v8, v19, v20, v8
v_max3_f32 v9, v27, v28, v9
v_mfma_f32_16x16x32_bf16 v[36:39], v[152:155], a[168:171], v[36:39]
v_max3_f32 v8, v21, v22, v8
v_max3_f32 v9, v29, v30, v9
v_mfma_f32_16x16x32_bf16 v[36:39], v[156:159], a[172:175], v[36:39]
v_max3_f32 v8, v23, v8, v8
v_max3_f32 v9, v31, v9, v9
v_mfma_f32_16x16x32_bf16 v[40:43], v[128:131], a[176:179], 0
v_mov_b32 v80, v8
v_mov_b32 v81, v9
v_mfma_f32_16x16x32_bf16 v[40:43], v[132:135], a[180:183], v[40:43]
s_nop 0
v_permlane16_swap_b32 v8, v80
v_mfma_f32_16x16x32_bf16 v[40:43], v[136:139], a[184:187], v[40:43]
v_permlane16_swap_b32 v9, v81
s_nop 0
v_mfma_f32_16x16x32_bf16 v[40:43], v[140:143], a[188:191], v[40:43]
v_max_f32 v8, v8, v80
v_max_f32 v9, v9, v81
v_mfma_f32_16x16x32_bf16 v[44:47], v[144:147], a[176:179], 0
v_mov_b32 v80, v8
v_mov_b32 v81, v9
v_mfma_f32_16x16x32_bf16 v[44:47], v[148:151], a[180:183], v[44:47]
s_nop 0
v_permlane32_swap_b32 v8, v80
v_mfma_f32_16x16x32_bf16 v[44:47], v[152:155], a[184:187], v[44:47]
v_permlane32_swap_b32 v9, v81
s_nop 0
v_mfma_f32_16x16x32_bf16 v[44:47], v[156:159], a[188:191], v[44:47]
v_max_f32 v8, v8, v80
v_max_f32 v9, v9, v81
v_sub_f32 v16, v16, v8
v_sub_f32 v24, v24, v9
v_sub_f32 v17, v17, v8
v_sub_f32 v25, v25, v9
buffer_load_dwordx4 v[184:187], v2, s[40:43], s44 offen offset:2048 sc1
v_sub_f32 v18, v18, v8
v_sub_f32 v26, v26, v9
v_sub_f32 v19, v19, v8
v_sub_f32 v27, v27, v9
buffer_load_dwordx4 v[188:191], v2, s[40:43], s44 offen offset:3072 sc1
v_sub_f32 v20, v20, v8
v_sub_f32 v28, v28, v9
v_sub_f32 v21, v21, v8
v_sub_f32 v29, v29, v9
buffer_load_dwordx4 v[224:227], v3, s[40:43], s44 offen offset:0 sc1
v_sub_f32 v22, v22, v8
v_sub_f32 v30, v30, v9
v_sub_f32 v23, v23, v8
v_sub_f32 v31, v31, v9
buffer_load_dwordx4 v[228:231], v3, s[40:43], s44 offen offset:1024 sc1
v_sub_f32 v48, 0, v8
v_sub_f32 v52, 0, v9
v_sub_f32 v49, 0, v8
v_sub_f32 v53, 0, v9
buffer_load_dwordx4 v[232:235], v3, s[40:43], s44 offen offset:2048 sc1
v_sub_f32 v50, 0, v8
v_sub_f32 v54, 0, v9
v_sub_f32 v51, 0, v8
v_sub_f32 v55, 0, v9
buffer_load_dwordx4 v[236:239], v3, s[40:43], s44 offen offset:3072 sc1
v_exp_f32 v80, v16
v_exp_f32 v81, v17
v_exp_f32 v82, v18
v_add_f32 v8, v80, v81
buffer_load_dwordx4 v[240:243], v4, s[40:43], s44 offen offset:0 sc1
v_exp_f32 v83, v19
v_add_f32 v8, v8, v82
v_exp_f32 v84, v20
v_add_f32 v8, v8, v83
buffer_load_dwordx4 v[244:247], v4, s[40:43], s44 offen offset:1024 sc1
v_exp_f32 v85, v21
v_add_f32 v8, v8, v84
v_exp_f32 v86, v22
v_add_f32 v8, v8, v85
buffer_load_dwordx4 v[248:251], v4, s[40:43], s44 offen offset:2048 sc1
v_exp_f32 v87, v23
v_add_f32 v8, v8, v86
v_exp_f32 v88, v24
v_add_f32 v8, v8, v87
buffer_load_dwordx4 v[252:255], v4, s[40:43], s44 offen offset:3072 sc1
v_exp_f32 v89, v25
v_exp_f32 v90, v26
v_add_f32 v9, v88, v89
v_exp_f32 v91, v27
v_add_f32 v9, v9, v90
v_exp_f32 v92, v28
v_add_f32 v9, v9, v91
v_exp_f32 v93, v29
v_add_f32 v9, v9, v92
v_exp_f32 v94, v30
v_add_f32 v9, v9, v93
v_exp_f32 v95, v31
v_add_f32 v9, v9, v94
v_cvt_pk_bf16_f32 v112, v80, v81
v_add_f32 v9, v9, v95
v_cvt_pk_bf16_f32 v113, v82, v83
v_cvt_pk_bf16_f32 v114, v84, v85
v_cvt_pk_bf16_f32 v115, v86, v87
v_cvt_pk_bf16_f32 v116, v88, v89
v_cvt_pk_bf16_f32 v117, v90, v91
v_cvt_pk_bf16_f32 v118, v92, v93
v_cvt_pk_bf16_f32 v119, v94, v95
v_max3_f32 v10, v32, v33, v34
v_max3_f32 v11, v40, v41, v42
v_max3_f32 v10, v35, v36, v10
v_max3_f32 v11, v43, v44, v11
v_max3_f32 v10, v37, v38, v10
v_max3_f32 v11, v45, v46, v11
v_max3_f32 v10, v39, v10, v10
v_max3_f32 v11, v47, v11, v11
v_mov_b32 v96, v10
v_mov_b32 v97, v11
s_nop 0
v_permlane16_swap_b32 v10, v96
v_permlane16_swap_b32 v11, v97
s_nop 0
v_max_f32 v10, v10, v96
v_max_f32 v11, v11, v97
v_mov_b32 v96, v10
v_mov_b32 v97, v11
s_nop 0
v_permlane32_swap_b32 v10, v96
v_permlane32_swap_b32 v11, v97
s_nop 0
v_max_f32 v10, v10, v96
v_max_f32 v11, v11, v97
v_sub_f32 v32, v32, v10
v_sub_f32 v40, v40, v11
v_sub_f32 v33, v33, v10
v_sub_f32 v41, v41, v11
v_sub_f32 v34, v34, v10
v_sub_f32 v42, v42, v11
v_sub_f32 v35, v35, v10
v_sub_f32 v43, v43, v11
v_sub_f32 v36, v36, v10
v_sub_f32 v44, v44, v11
v_sub_f32 v37, v37, v10
v_sub_f32 v45, v45, v11
v_sub_f32 v38, v38, v10
v_sub_f32 v46, v46, v11
v_sub_f32 v39, v39, v10
v_sub_f32 v47, v47, v11
v_sub_f32 v56, 0, v10
v_sub_f32 v60, 0, v11
v_sub_f32 v57, 0, v10
v_sub_f32 v61, 0, v11
v_sub_f32 v58, 0, v10
v_sub_f32 v62, 0, v11
v_sub_f32 v59, 0, v10
v_sub_f32 v63, 0, v11
s_mov_b32 m0, 2
s_mov_b32 s44, s50
s_waitcnt vmcnt(16)
v_mov_b32 v15, s35
s_mov_b64 exec, 1
global_store_dword v0, v15, s[30:31] sc1
s_mov_b64 exec, -1
v_mfma_f32_16x16x32_bf16 a[0:3], v[192:195], v[112:115], 0
v_exp_f32 v96, v32
v_mfma_f32_16x16x32_bf16 a[32:35], v[192:195], v[116:119], 0
v_exp_f32 v97, v33
v_mfma_f32_16x16x32_bf16 a[4:7], v[196:199], v[112:115], 0
buffer_load_dwordx4 v[128:131], v1, s[40:43], s44 offen offset:0 sc1
v_mfma_f32_16x16x32_bf16 a[36:39], v[196:199], v[116:119], 0
buffer_load_dwordx4 v[132:135], v1, s[40:43], s44 offen offset:1024 sc1
v_mfma_f32_16x16x32_bf16 a[8:11], v[200:203], v[112:115], 0
v_exp_f32 v98, v34
v_mfma_f32_16x16x32_bf16 a[40:43], v[200:203], v[116:119], 0
v_exp_f32 v99, v35
v_mfma_f32_16x16x32_bf16 a[12:15], v[204:207], v[112:115], 0
v_add_f32 v64, v64, v8
v_add_f32 v65, v65, v9
v_add_f32 v10, v96, v97
v_mfma_f32_16x16x32_bf16 a[44:47], v[204:207], v[116:119], 0
buffer_load_dwordx4 v[136:139], v1, s[40:43], s44 offen offset:2048 sc1
v_mfma_f32_16x16x32_bf16 a[16:19], v[208:211], v[112:115], 0
v_exp_f32 v100, v36
v_mfma_f32_16x16x32_bf16 a[48:51], v[208:211], v[116:119], 0
v_exp_f32 v101, v37
v_mfma_f32_16x16x32_bf16 a[20:23], v[212:215], v[112:115], 0
v_add_f32 v10, v10, v98
v_add_f32 v10, v10, v99
v_cvt_pk_bf16_f32 v120, v96, v97
v_mfma_f32_16x16x32_bf16 a[52:55], v[212:215], v[116:119], 0
buffer_load_dwordx4 v[140:143], v1, s[40:43], s44 offen offset:3072 sc1
v_mfma_f32_16x16x32_bf16 a[24:27], v[216:219], v[112:115], 0
s_waitcnt vmcnt(13)
v_exp_f32 v102, v38
v_mfma_f32_16x16x32_bf16 a[56:59], v[216:219], v[116:119], 0
v_exp_f32 v103, v39
v_mfma_f32_16x16x32_bf16 a[28:31], v[220:223], v[112:115], 0
v_add_f32 v10, v10, v100
v_add_f32 v10, v10, v101
v_cvt_pk_bf16_f32 v121, v98, v99
v_mfma_f32_16x16x32_bf16 a[60:63], v[220:223], v[116:119], 0
buffer_load_dwordx4 v[144:147], v2, s[40:43], s44 offen offset:0 sc1
global_load_dword v0, v6, s[30:31] sc1
s_mov_b32 s29, 4
s_mov_b32 s28, 3
.p2align 6
L_loop:
v_mfma_f32_16x16x32_bf16 v[16:19], v[160:163], a[128:131], v[48:51]
v_exp_f32 v104, v40
v_mfma_f32_16x16x32_bf16 v[16:19], v[164:167], a[132:135], v[16:19]
v_exp_f32 v105, v41
v_mfma_f32_16x16x32_bf16 v[16:19], v[168:171], a[136:139], v[16:19]
v_add_f32 v10, v10, v102
v_add_f32 v10, v10, v103
v_cvt_pk_bf16_f32 v122, v100, v101
v_mfma_f32_16x16x32_bf16 v[16:19], v[172:175], a[140:143], v[16:19]
buffer_load_dwordx4 v[148:151], v2, s[40:43], s44 offen offset:1024 sc1
v_mfma_f32_16x16x32_bf16 v[20:23], v[176:179], a[128:131], v[48:51]
v_exp_f32 v106, v42
v_mfma_f32_16x16x32_bf16 v[20:23], v[180:183], a[132:135], v[20:23]
v_exp_f32 v107, v43
v_mfma_f32_16x16x32_bf16 v[20:23], v[184:187], a[136:139], v[20:23]
v_add_f32 v11, v104, v105
v_cvt_pk_bf16_f32 v123, v102, v103
v_cvt_pk_bf16_f32 v124, v104, v105
v_mfma_f32_16x16x32_bf16 v[20:23], v[188:191], a[140:143], v[20:23]
buffer_load_dwordx4 v[152:155], v2, s[40:43], s44 offen offset:2048 sc1
v_mfma_f32_16x16x32_bf16 v[24:27], v[160:163], a[144:147], v[52:55]
v_exp_f32 v108, v44
v_mfma_f32_16x16x32_bf16 v[24:27], v[164:167], a[148:151], v[24:27]
v_exp_f32 v109, v45
v_mfma_f32_16x16x32_bf16 v[24:27], v[168:171], a[152:155], v[24:27]
buffer_load_dwordx4 v[156:159], v2, s[40:43], s44 offen offset:3072 sc1
v_mfma_f32_16x16x32_bf16 v[24:27], v[172:175], a[156:159], v[24:27]
v_add_f32 v11, v11, v106
v_add_f32 v11, v11, v107
v_cvt_pk_bf16_f32 v125, v106, v107
v_mfma_f32_16x16x32_bf16 v[28:31], v[176:179], a[144:147], v[52:55]
v_exp_f32 v110, v46
v_mfma_f32_16x16x32_bf16 v[28:31], v[180:183], a[148:151], v[28:31]
v_exp_f32 v111, v47
v_mfma_f32_16x16x32_bf16 v[28:31], v[184:187], a[152:155], v[28:31]
v_add_f32 v11, v11, v108
v_add_f32 v11, v11, v109
v_add_f32 v11, v11, v110
v_cvt_pk_bf16_f32 v126, v108, v109
v_mfma_f32_16x16x32_bf16 v[28:31], v[188:191], a[156:159], v[28:31]
v_add_f32 v11, v11, v111
v_cvt_pk_bf16_f32 v127, v110, v111
v_add_f32 v68, v10, v11
v_cmp_nge_f32 vcc, s45, v68
s_cbranch_vccnz L_slow_b_13
L_ret_b_14:
v_mfma_f32_16x16x32_bf16 a[64:67], v[192:195], v[120:123], a[64:67]
v_exp_f32 v80, v16
v_mfma_f32_16x16x32_bf16 a[96:99], v[192:195], v[124:127], a[96:99]
v_exp_f32 v81, v17
v_mfma_f32_16x16x32_bf16 a[68:71], v[196:199], v[120:123], a[68:71]
buffer_load_dwordx4 v[192:195], v3, s[40:43], s44 offen offset:0 sc1
v_mfma_f32_16x16x32_bf16 a[100:103], v[196:199], v[124:127], a[100:103]
buffer_load_dwordx4 v[196:199], v3, s[40:43], s44 offen offset:1024 sc1
v_mfma_f32_16x16x32_bf16 a[72:75], v[200:203], v[120:123], a[72:75]
v_exp_f32 v82, v18
v_mfma_f32_16x16x32_bf16 a[104:107], v[200:203], v[124:127], a[104:107]
v_exp_f32 v83, v19
v_mfma_f32_16x16x32_bf16 a[76:79], v[204:207], v[120:123], a[76:79]
v_add_f32 v66, v66, v10
v_add_f32 v67, v67, v11
v_add_f32 v8, v80, v81
v_mfma_f32_16x16x32_bf16 a[108:111], v[204:207], v[124:127], a[108:111]
buffer_load_dwordx4 v[200:203], v3, s[40:43], s44 offen offset:2048 sc1
v_mfma_f32_16x16x32_bf16 a[80:83], v[208:211], v[120:123], a[80:83]
v_exp_f32 v84, v20
v_mfma_f32_16x16x32_bf16 a[112:115], v[208:211], v[124:127], a[112:115]
v_exp_f32 v85, v21
v_mfma_f32_16x16x32_bf16 a[84:87], v[212:215], v[120:123], a[84:87]
v_add_f32 v8, v8, v82
v_add_f32 v8, v8, v83
v_cvt_pk_bf16_f32 v112, v80, v81
v_mfma_f32_16x16x32_bf16 a[116:119], v[212:215], v[124:127], a[116:119]
buffer_load_dwordx4 v[204:207], v3, s[40:43], s44 offen offset:3072 sc1
v_mfma_f32_16x16x32_bf16 a[88:91], v[216:219], v[120:123], a[88:91]
v_exp_f32 v86, v22
v_mfma_f32_16x16x32_bf16 a[120:123], v[216:219], v[124:127], a[120:123]
v_exp_f32 v87, v23
v_mfma_f32_16x16x32_bf16 a[92:95], v[220:223], v[120:123], a[92:95]
v_add_f32 v8, v8, v84
v_add_f32 v8, v8, v85
v_cvt_pk_bf16_f32 v113, v82, v83
v_mfma_f32_16x16x32_bf16 a[124:127], v[220:223], v[124:127], a[124:127]
buffer_load_dwordx4 v[208:211], v4, s[40:43], s44 offen offset:0 sc1
v_mfma_f32_16x16x32_bf16 v[32:35], v[160:163], a[160:163], v[56:59]
v_exp_f32 v88, v24
v_mfma_f32_16x16x32_bf16 v[32:35], v[164:167], a[164:167], v[32:35]
v_exp_f32 v89, v25
v_mfma_f32_16x16x32_bf16 v[32:35], v[168:171], a[168:171], v[32:35]
v_add_f32 v8, v8, v86
v_add_f32 v8, v8, v87
v_cvt_pk_bf16_f32 v114, v84, v85
v_mfma_f32_16x16x32_bf16 v[32:35], v[172:175], a[172:175], v[32:35]
buffer_load_dwordx4 v[212:215], v4, s[40:43], s44 offen offset:1024 sc1
v_mfma_f32_16x16x32_bf16 v[36:39], v[176:179], a[160:163], v[56:59]
v_exp_f32 v90, v26
v_mfma_f32_16x16x32_bf16 v[36:39], v[180:183], a[164:167], v[36:39]
v_exp_f32 v91, v27
v_mfma_f32_16x16x32_bf16 v[36:39], v[184:187], a[168:171], v[36:39]
v_add_f32 v9, v88, v89
v_cvt_pk_bf16_f32 v115, v86, v87
v_cvt_pk_bf16_f32 v116, v88, v89
v_mfma_f32_16x16x32_bf16 v[36:39], v[188:191], a[172:175], v[36:39]
buffer_load_dwordx4 v[216:219], v4, s[40:43], s44 offen offset:2048 sc1
v_mfma_f32_16x16x32_bf16 v[40:43], v[160:163], a[176:179], v[60:63]
s_add_u32 m0, m0, 1
v_exp_f32 v92, v28
v_mfma_f32_16x16x32_bf16 v[40:43], v[164:167], a[180:183], v[40:43]
s_waitcnt vmcnt(15)
v_exp_f32 v93, v29
v_mfma_f32_16x16x32_bf16 v[40:43], v[168:171], a[184:187], v[40:43]
buffer_load_dwordx4 v[220:223], v4, s[40:43], s44 offen offset:3072 sc1
v_mfma_f32_16x16x32_bf16 v[40:43], v[172:175], a[188:191], v[40:43]
v_add_f32 v9, v9, v90
v_add_f32 v9, v9, v91
v_cvt_pk_bf16_f32 v117, v90, v91
v_mfma_f32_16x16x32_bf16 v[44:47], v[176:179], a[176:179], v[60:63]
s_movrels_b32 s44, s48
v_exp_f32 v94, v30
v_mfma_f32_16x16x32_bf16 v[44:47], v[180:183], a[180:183], v[44:47]
v_exp_f32 v95, v31
v_mfma_f32_16x16x32_bf16 v[44:47], v[184:187], a[184:187], v[44:47]
v_add_f32 v9, v9, v92
v_add_f32 v9, v9, v93
v_add_f32 v9, v9, v94
v_cvt_pk_bf16_f32 v118, v92, v93
v_mfma_f32_16x16x32_bf16 v[44:47], v[188:191], a[188:191], v[44:47]
v_add_f32 v9, v9, v95
v_cvt_pk_bf16_f32 v119, v94, v95
v_add_f32 v68, v8, v9
v_cmp_nge_f32 vcc, s45, v68
s_cbranch_vccnz L_slow_a_15
L_ret_a_16:
v_mfma_f32_16x16x32_bf16 a[0:3], v[224:227], v[112:115], a[0:3]
v_exp_f32 v96, v32
v_mfma_f32_16x16x32_bf16 a[32:35], v[224:227], v[116:119], a[32:35]
v_exp_f32 v97, v33
v_mfma_f32_16x16x32_bf16 a[4:7], v[228:231], v[112:115], a[4:7]
buffer_load_dwordx4 v[160:163], v1, s[40:43], s44 offen offset:0 sc1
v_mfma_f32_16x16x32_bf16 a[36:39], v[228:231], v[116:119], a[36:39]
buffer_load_dwordx4 v[164:167], v1, s[40:43], s44 offen offset:1024 sc1
v_mfma_f32_16x16x32_bf16 a[8:11], v[232:235], v[112:115], a[8:11]
v_exp_f32 v98, v34
v_mfma_f32_16x16x32_bf16 a[40:43], v[232:235], v[116:119], a[40:43]
v_exp_f32 v99, v35
v_mfma_f32_16x16x32_bf16 a[12:15], v[236:239], v[112:115], a[12:15]
v_add_f32 v64, v64, v8
v_add_f32 v65, v65, v9
v_add_f32 v10, v96, v97
v_mfma_f32_16x16x32_bf16 a[44:47], v[236:239], v[116:119], a[44:47]
buffer_load_dwordx4 v[168:171], v1, s[40:43], s44 offen offset:2048 sc1
v_mfma_f32_16x16x32_bf16 a[16:19], v[240:243], v[112:115], a[16:19]
v_exp_f32 v100, v36
v_mfma_f32_16x16x32_bf16 a[48:51], v[240:243], v[116:119], a[48:51]
v_exp_f32 v101, v37
v_mfma_f32_16x16x32_bf16 a[20:23], v[244:247], v[112:115], a[20:23]
v_add_f32 v10, v10, v98
v_add_f32 v10, v10, v99
v_cvt_pk_bf16_f32 v120, v96, v97
v_mfma_f32_16x16x32_bf16 a[52:55], v[244:247], v[116:119], a[52:55]
buffer_load_dwordx4 v[172:175], v1, s[40:43], s44 offen offset:3072 sc1
v_mfma_f32_16x16x32_bf16 a[24:27], v[248:251], v[112:115], a[24:27]
s_waitcnt vmcnt(12)
v_exp_f32 v102, v38
v_mfma_f32_16x16x32_bf16 a[56:59], v[248:251], v[116:119], a[56:59]
v_exp_f32 v103, v39
v_mfma_f32_16x16x32_bf16 a[28:31], v[252:255], v[112:115], a[28:31]
v_add_f32 v10, v10, v100
v_add_f32 v10, v10, v101
v_cvt_pk_bf16_f32 v121, v98, v99
v_mfma_f32_16x16x32_bf16 a[60:63], v[252:255], v[116:119], a[60:63]
buffer_load_dwordx4 v[176:179], v2, s[40:43], s44 offen offset:0 sc1
s_cmp_eq_u32 m0, 3
s_cbranch_scc1 L_hook
L_mid:
v_mfma_f32_16x16x32_bf16 v[16:19], v[128:131], a[128:131], v[48:51]
v_exp_f32 v104, v40
v_mfma_f32_16x16x32_bf16 v[16:19], v[132:135], a[132:135], v[16:19]
v_exp_f32 v105, v41
v_mfma_f32_16x16x32_bf16 v[16:19], v[136:139], a[136:139], v[16:19]
v_add_f32 v10, v10, v102
v_add_f32 v10, v10, v103
v_cvt_pk_bf16_f32 v122, v100, v101
v_mfma_f32_16x16x32_bf16 v[16:19], v[140:143], a[140:143], v[16:19]
buffer_load_dwordx4 v[180:183], v2, s[40:43], s44 offen offset:1024 sc1
v_mfma_f32_16x16x32_bf16 v[20:23], v[144:147], a[128:131], v[48:51]
v_exp_f32 v106, v42
v_mfma_f32_16x16x32_bf16 v[20:23], v[148:151], a[132:135], v[20:23]
v_exp_f32 v107, v43
v_mfma_f32_16x16x32_bf16 v[20:23], v[152:155], a[136:139], v[20:23]
v_add_f32 v11, v104, v105
v_cvt_pk_bf16_f32 v123, v102, v103
v_cvt_pk_bf16_f32 v124, v104, v105
v_mfma_f32_16x16x32_bf16 v[20:23], v[156:159], a[140:143], v[20:23]
buffer_load_dwordx4 v[184:187], v2, s[40:43], s44 offen offset:2048 sc1
v_mfma_f32_16x16x32_bf16 v[24:27], v[128:131], a[144:147], v[52:55]
v_exp_f32 v108, v44
v_mfma_f32_16x16x32_bf16 v[24:27], v[132:135], a[148:151], v[24:27]
v_exp_f32 v109, v45
v_mfma_f32_16x16x32_bf16 v[24:27], v[136:139], a[152:155], v[24:27]
buffer_load_dwordx4 v[188:191], v2, s[40:43], s44 offen offset:3072 sc1
v_mfma_f32_16x16x32_bf16 v[24:27], v[140:143], a[156:159], v[24:27]
v_add_f32 v11, v11, v106
v_add_f32 v11, v11, v107
v_cvt_pk_bf16_f32 v125, v106, v107
v_mfma_f32_16x16x32_bf16 v[28:31], v[144:147], a[144:147], v[52:55]
v_exp_f32 v110, v46
v_mfma_f32_16x16x32_bf16 v[28:31], v[148:151], a[148:151], v[28:31]
v_exp_f32 v111, v47
v_mfma_f32_16x16x32_bf16 v[28:31], v[152:155], a[152:155], v[28:31]
v_add_f32 v11, v11, v108
v_add_f32 v11, v11, v109
v_add_f32 v11, v11, v110
v_cvt_pk_bf16_f32 v126, v108, v109
v_mfma_f32_16x16x32_bf16 v[28:31], v[156:159], a[156:159], v[28:31]
v_add_f32 v11, v11, v111
v_cvt_pk_bf16_f32 v127, v110, v111
v_add_f32 v68, v10, v11
v_cmp_nge_f32 vcc, s45, v68
s_cbranch_vccnz L_slow_b_17
L_ret_b_18:
v_mfma_f32_16x16x32_bf16 a[64:67], v[224:227], v[120:123], a[64:67]
v_exp_f32 v80, v16
v_mfma_f32_16x16x32_bf16 a[96:99], v[224:227], v[124:127], a[96:99]
v_exp_f32 v81, v17
v_mfma_f32_16x16x32_bf16 a[68:71], v[228:231], v[120:123], a[68:71]
buffer_load_dwordx4 v[224:227], v3, s[40:43], s44 offen offset:0 sc1
v_mfma_f32_16x16x32_bf16 a[100:103], v[228:231], v[124:127], a[100:103]
buffer_load_dwordx4 v[228:231], v3, s[40:43], s44 offen offset:1024 sc1
v_mfma_f32_16x16x32_bf16 a[72:75], v[232:235], v[120:123], a[72:75]
v_exp_f32 v82, v18
v_mfma_f32_16x16x32_bf16 a[104:107], v[232:235], v[124:127], a[104:107]
v_exp_f32 v83, v19
v_mfma_f32_16x16x32_bf16 a[76:79], v[236:239], v[120:123], a[76:79]
v_add_f32 v66, v66, v10
v_add_f32 v67, v67, v11
v_add_f32 v8, v80, v81
v_mfma_f32_16x16x32_bf16 a[108:111], v[236:239], v[124:127], a[108:111]
buffer_load_dwordx4 v[232:235], v3, s[40:43], s44 offen offset:2048 sc1
v_mfma_f32_16x16x32_bf16 a[80:83], v[240:243], v[120:123], a[80:83]
v_exp_f32 v84, v20
v_mfma_f32_16x16x32_bf16 a[112:115], v[240:243], v[124:127], a[112:115]
v_exp_f32 v85, v21
v_mfma_f32_16x16x32_bf16 a[84:87], v[244:247], v[120:123], a[84:87]
v_add_f32 v8, v8, v82
v_add_f32 v8, v8, v83
v_cvt_pk_bf16_f32 v112, v80, v81
v_mfma_f32_16x16x32_bf16 a[116:119], v[244:247], v[124:127], a[116:119]
buffer_load_dwordx4 v[236:239], v3, s[40:43], s44 offen offset:3072 sc1
v_mfma_f32_16x16x32_bf16 a[88:91], v[248:251], v[120:123], a[88:91]
v_exp_f32 v86, v22
v_mfma_f32_16x16x32_bf16 a[120:123], v[248:251], v[124:127], a[120:123]
v_exp_f32 v87, v23
v_mfma_f32_16x16x32_bf16 a[92:95], v[252:255], v[120:123], a[92:95]
v_add_f32 v8, v8, v84
v_add_f32 v8, v8, v85
v_cvt_pk_bf16_f32 v113, v82, v83
v_mfma_f32_16x16x32_bf16 a[124:127], v[252:255], v[124:127], a[124:127]
buffer_load_dwordx4 v[240:243], v4, s[40:43], s44 offen offset:0 sc1
v_mfma_f32_16x16x32_bf16 v[32:35], v[128:131], a[160:163], v[56:59]
v_exp_f32 v88, v24
v_mfma_f32_16x16x32_bf16 v[32:35], v[132:135], a[164:167], v[32:35]
v_exp_f32 v89, v25
v_mfma_f32_16x16x32_bf16 v[32:35], v[136:139], a[168:171], v[32:35]
v_add_f32 v8, v8, v86
v_add_f32 v8, v8, v87
v_cvt_pk_bf16_f32 v114, v84, v85
v_mfma_f32_16x16x32_bf16 v[32:35], v[140:143], a[172:175], v[32:35]
buffer_load_dwordx4 v[244:247], v4, s[40:43], s44 offen offset:1024 sc1
v_mfma_f32_16x16x32_bf16 v[36:39], v[144:147], a[160:163], v[56:59]
v_exp_f32 v90, v26
v_mfma_f32_16x16x32_bf16 v[36:39], v[148:151], a[164:167], v[36:39]
v_exp_f32 v91, v27
v_mfma_f32_16x16x32_bf16 v[36:39], v[152:155], a[168:171], v[36:39]
v_add_f32 v9, v88, v89
v_cvt_pk_bf16_f32 v115, v86, v87
v_cvt_pk_bf16_f32 v116, v88, v89
v_mfma_f32_16x16x32_bf16 v[36:39], v[156:159], a[172:175], v[36:39]
buffer_load_dwordx4 v[248:251], v4, s[40:43], s44 offen offset:2048 sc1
v_mfma_f32_16x16x32_bf16 v[40:43], v[128:131], a[176:179], v[60:63]
s_add_u32 m0, m0, 1
v_exp_f32 v92, v28
v_mfma_f32_16x16x32_bf16 v[40:43], v[132:135], a[180:183], v[40:43]
s_waitcnt vmcnt(15)
v_exp_f32 v93, v29
v_mfma_f32_16x16x32_bf16 v[40:43], v[136:139], a[184:187], v[40:43]
buffer_load_dwordx4 v[252:255], v4, s[40:43], s44 offen offset:3072 sc1
v_mfma_f32_16x16x32_bf16 v[40:43], v[140:143], a[188:191], v[40:43]
v_add_f32 v9, v9, v90
v_add_f32 v9, v9, v91
v_cvt_pk_bf16_f32 v117, v90, v91
v_mfma_f32_16x16x32_bf16 v[44:47], v[144:147], a[176:179], v[60:63]
s_movrels_b32 s44, s48
v_exp_f32 v94, v30
v_mfma_f32_16x16x32_bf16 v[44:47], v[148:151], a[180:183], v[44:47]
v_exp_f32 v95, v31
v_mfma_f32_16x16x32_bf16 v[44:47], v[152:155], a[184:187], v[44:47]
v_add_f32 v9, v9, v92
v_add_f32 v9, v9, v93
v_add_f32 v9, v9, v94
v_cvt_pk_bf16_f32 v118, v92, v93
v_mfma_f32_16x16x32_bf16 v[44:47], v[156:159], a[188:191], v[44:47]
v_add_f32 v9, v9, v95
v_cvt_pk_bf16_f32 v119, v94, v95
v_add_f32 v68, v8, v9
v_cmp_nge_f32 vcc, s45, v68
s_cbranch_vccnz L_slow_a_19
L_ret_a_20:
v_mfma_f32_16x16x32_bf16 a[0:3], v[192:195], v[112:115], a[0:3]
v_exp_f32 v96, v32
v_mfma_f32_16x16x32_bf16 a[32:35], v[192:195], v[116:119], a[32:35]
v_exp_f32 v97, v33
v_mfma_f32_16x16x32_bf16 a[4:7], v[196:199], v[112:115], a[4:7]
buffer_load_dwordx4 v[128:131], v1, s[40:43], s44 offen offset:0 sc1
v_mfma_f32_16x16x32_bf16 a[36:39], v[196:199], v[116:119], a[36:39]
buffer_load_dwordx4 v[132:135], v1, s[40:43], s44 offen offset:1024 sc1
v_mfma_f32_16x16x32_bf16 a[8:11], v[200:203], v[112:115], a[8:11]
v_exp_f32 v98, v34
v_mfma_f32_16x16x32_bf16 a[40:43], v[200:203], v[116:119], a[40:43]
v_exp_f32 v99, v35
v_mfma_f32_16x16x32_bf16 a[12:15], v[204:207], v[112:115], a[12:15]
v_add_f32 v64, v64, v8
v_add_f32 v65, v65, v9
v_add_f32 v10, v96, v97
v_mfma_f32_16x16x32_bf16 a[44:47], v[204:207], v[116:119], a[44:47]
buffer_load_dwordx4 v[136:139], v1, s[40:43], s44 offen offset:2048 sc1
v_mfma_f32_16x16x32_bf16 a[16:19], v[208:211], v[112:115], a[16:19]
v_exp_f32 v100, v36
v_mfma_f32_16x16x32_bf16 a[48:51], v[208:211], v[116:119], a[48:51]
v_exp_f32 v101, v37
v_mfma_f32_16x16x32_bf16 a[20:23], v[212:215], v[112:115], a[20:23]
v_add_f32 v10, v10, v98
v_add_f32 v10, v10, v99
v_cvt_pk_bf16_f32 v120, v96, v97
v_mfma_f32_16x16x32_bf16 a[52:55], v[212:215], v[116:119], a[52:55]
buffer_load_dwordx4 v[140:143], v1, s[40:43], s44 offen offset:3072 sc1
v_mfma_f32_16x16x32_bf16 a[24:27], v[216:219], v[112:115], a[24:27]
s_waitcnt vmcnt(12)
v_exp_f32 v102, v38
v_mfma_f32_16x16x32_bf16 a[56:59], v[216:219], v[116:119], a[56:59]
v_exp_f32 v103, v39
v_mfma_f32_16x16x32_bf16 a[28:31], v[220:223], v[112:115], a[28:31]
v_add_f32 v10, v10, v100
v_add_f32 v10, v10, v101
v_cvt_pk_bf16_f32 v121, v98, v99
v_mfma_f32_16x16x32_bf16 a[60:63], v[220:223], v[116:119], a[60:63]
buffer_load_dwordx4 v[144:147], v2, s[40:43], s44 offen offset:0 sc1
s_cmp_lt_u32 m0, s29
s_cbranch_scc1 L_loop
s_cmp_eq_u32 m0, 16
s_cbranch_scc1 L_tail
s_cmp_eq_u32 m0, 6
s_cbranch_scc1 L_ev2
s_cmp_eq_u32 m0, 4
s_cbranch_scc1 L_ev1
s_getpc_b64 s[36:37]
L_pc2:
v_lshlrev_b32 v12, 7, v5
v_min_u32 v12, L_end-L_pc2, v12
global_load_dword v0, v12, s[36:37]
s_mov_b32 s29, 16
s_branch L_loop
L_ev1:
v_and_b32 v12, 4, v5
v_cmp_eq_u32 vcc, 0, v12
v_xor_b32 v13, 512, v6
v_add_u32 v14, 128, v6
v_cndmask_b32 v6, v14, v13, vcc
global_load_dword v0, v6, s[30:31] sc1
s_mov_b32 s29, 6
s_branch L_loop
L_ev2:
s_mov_b32 s29, 12
v_cmp_ne_u32 vcc, s35, v0
s_cbranch_vccz L_loop
s_mov_b32 s3, 0
L_poll_21:
global_load_dword v12, v6, s[30:31] sc1
s_add_u32 s3, s3, 1
s_waitcnt vmcnt(0)
v_cmp_ne_u32 vcc, s35, v12
s_cbranch_vccz L_polled_22
s_sleep 1
s_cmp_lt_u32 s3, 0x8000
s_cbranch_scc1 L_poll_21
L_polled_22:
s_branch L_loop
L_hook:
s_waitcnt vmcnt(16)
v_cmp_ne_u32 vcc, s35, v0
s_cbranch_vccz L_mid
s_mov_b32 s3, 0
L_poll_23:
global_load_dword v12, v6, s[30:31] sc1
s_add_u32 s3, s3, 1
s_waitcnt vmcnt(0)
v_cmp_ne_u32 vcc, s35, v12
s_cbranch_vccz L_polled_24
s_sleep 1
s_cmp_lt_u32 s3, 0x8000
s_cbranch_scc1 L_poll_23
L_polled_24:
s_branch L_mid
L_tail:
v_mfma_f32_16x16x32_bf16 v[16:19], v[160:163], a[128:131], v[48:51]
v_exp_f32 v104, v40
v_mfma_f32_16x16x32_bf16 v[16:19], v[164:167], a[132:135], v[16:19]
v_exp_f32 v105, v41
v_mfma_f32_16x16x32_bf16 v[16:19], v[168:171], a[136:139], v[16:19]
v_add_f32 v10, v10, v102
v_add_f32 v10, v10, v103
v_cvt_pk_bf16_f32 v122, v100, v101
v_mfma_f32_16x16x32_bf16 v[16:19], v[172:175], a[140:143], v[16:19]
v_mfma_f32_16x16x32_bf16 v[20:23], v[176:179], a[128:131], v[48:51]
v_exp_f32 v106, v42
v_mfma_f32_16x16x32_bf16 v[20:23], v[180:183], a[132:135], v[20:23]
v_exp_f32 v107, v43
v_mfma_f32_16x16x32_bf16 v[20:23], v[184:187], a[136:139], v[20:23]
v_add_f32 v11, v104, v105
v_cvt_pk_bf16_f32 v123, v102, v103
v_cvt_pk_bf16_f32 v124, v104, v105
v_mfma_f32_16x16x32_bf16 v[20:23], v[188:191], a[140:143], v[20:23]
v_mfma_f32_16x16x32_bf16 v[24:27], v[160:163], a[144:147], v[52:55]
v_exp_f32 v108, v44
v_mfma_f32_16x16x32_bf16 v[24:27], v[164:167], a[148:151], v[24:27]
v_exp_f32 v109, v45
v_mfma_f32_16x16x32_bf16 v[24:27], v[168:171], a[152:155], v[24:27]
v_mfma_f32_16x16x32_bf16 v[24:27], v[172:175], a[156:159], v[24:27]
v_add_f32 v11, v11, v106
v_add_f32 v11, v11, v107
v_cvt_pk_bf16_f32 v125, v106, v107
v_mfma_f32_16x16x32_bf16 v[28:31], v[176:179], a[144:147], v[52:55]
v_exp_f32 v110, v46
v_mfma_f32_16x16x32_bf16 v[28:31], v[180:183], a[148:151], v[28:31]
v_exp_f32 v111, v47
v_mfma_f32_16x16x32_bf16 v[28:31], v[184:187], a[152:155], v[28:31]
v_add_f32 v11, v11, v108
v_add_f32 v11, v11, v109
v_add_f32 v11, v11, v110
v_cvt_pk_bf16_f32 v126, v108, v109
v_mfma_f32_16x16x32_bf16 v[28:31], v[188:191], a[156:159], v[28:31]
v_add_f32 v11, v11, v111
v_cvt_pk_bf16_f32 v127, v110, v111
v_add_f32 v68, v10, v11
v_cmp_nge_f32 vcc, s45, v68
s_cbranch_vccnz L_slow_b_25
L_ret_b_26:
v_mfma_f32_16x16x32_bf16 a[64:67], v[192:195], v[120:123], a[64:67]
v_exp_f32 v80, v16
v_mfma_f32_16x16x32_bf16 a[96:99], v[192:195], v[124:127], a[96:99]
v_exp_f32 v81, v17
v_mfma_f32_16x16x32_bf16 a[68:71], v[196:199], v[120:123], a[68:71]
v_mfma_f32_16x16x32_bf16 a[100:103], v[196:199], v[124:127], a[100:103]
v_mfma_f32_16x16x32_bf16 a[72:75], v[200:203], v[120:123], a[72:75]
v_exp_f32 v82, v18
v_mfma_f32_16x16x32_bf16 a[104:107], v[200:203], v[124:127], a[104:107]
v_exp_f32 v83, v19
v_mfma_f32_16x16x32_bf16 a[76:79], v[204:207], v[120:123], a[76:79]
v_add_f32 v66, v66, v10
v_add_f32 v67, v67, v11
v_add_f32 v8, v80, v81
v_mfma_f32_16x16x32_bf16 a[108:111], v[204:207], v[124:127], a[108:111]
v_mfma_f32_16x16x32_bf16 a[80:83], v[208:211], v[120:123], a[80:83]
v_exp_f32 v84, v20
v_mfma_f32_16x16x32_bf16 a[112:115], v[208:211], v[124:127], a[112:115]
v_exp_f32 v85, v21
v_mfma_f32_16x16x32_bf16 a[84:87], v[212:215], v[120:123], a[84:87]
v_add_f32 v8, v8, v82
v_add_f32 v8, v8, v83
v_cvt_pk_bf16_f32 v112, v80, v81
v_mfma_f32_16x16x32_bf16 a[116:119], v[212:215], v[124:127], a[116:119]
v_mfma_f32_16x16x32_bf16 a[88:91], v[216:219], v[120:123], a[88:91]
v_exp_f32 v86, v22
v_mfma_f32_16x16x32_bf16 a[120:123], v[216:219], v[124:127], a[120:123]
v_exp_f32 v87, v23
v_mfma_f32_16x16x32_bf16 a[92:95], v[220:223], v[120:123], a[92:95]
v_add_f32 v8, v8, v84
v_add_f32 v8, v8, v85
v_cvt_pk_bf16_f32 v113, v82, v83
v_mfma_f32_16x16x32_bf16 a[124:127], v[220:223], v[124:127], a[124:127]
v_mfma_f32_16x16x32_bf16 v[32:35], v[160:163], a[160:163], v[56:59]
v_exp_f32 v88, v24
v_mfma_f32_16x16x32_bf16 v[32:35], v[164:167], a[164:167], v[32:35]
v_exp_f32 v89, v25
v_mfma_f32_16x16x32_bf16 v[32:35], v[168:171], a[168:171], v[32:35]
v_add_f32 v8, v8, v86
v_add_f32 v8, v8, v87
v_cvt_pk_bf16_f32 v114, v84, v85
v_mfma_f32_16x16x32_bf16 v[32:35], v[172:175], a[172:175], v[32:35]
v_mfma_f32_16x16x32_bf16 v[36:39], v[176:179], a[160:163], v[56:59]
v_exp_f32 v90, v26
v_mfma_f32_16x16x32_bf16 v[36:39], v[180:183], a[164:167], v[36:39]
v_exp_f32 v91, v27
v_mfma_f32_16x16x32_bf16 v[36:39], v[184:187], a[168:171], v[36:39]
v_add_f32 v9, v88, v89
v_cvt_pk_bf16_f32 v115, v86, v87
v_cvt_pk_bf16_f32 v116, v88, v89
v_mfma_f32_16x16x32_bf16 v[36:39], v[188:191], a[172:175], v[36:39]
v_mfma_f32_16x16x32_bf16 v[40:43], v[160:163], a[176:179], v[60:63]
v_exp_f32 v92, v28
v_mfma_f32_16x16x32_bf16 v[40:43], v[164:167], a[180:183], v[40:43]
s_waitcnt vmcnt(0)
v_exp_f32 v93, v29
v_mfma_f32_16x16x32_bf16 v[40:43], v[168:171], a[184:187], v[40:43]
v_mfma_f32_16x16x32_bf16 v[40:43], v[172:175], a[188:191], v[40:43]
v_add_f32 v9, v9, v90
v_add_f32 v9, v9, v91
v_cvt_pk_bf16_f32 v117, v90, v91
v_mfma_f32_16x16x32_bf16 v[44:47], v[176:179], a[176:179], v[60:63]
v_exp_f32 v94, v30
v_mfma_f32_16x16x32_bf16 v[44:47], v[180:183], a[180:183], v[44:47]
v_exp_f32 v95, v31
v_mfma_f32_16x16x32_bf16 v[44:47], v[184:187], a[184:187], v[44:47]
v_add_f32 v9, v9, v92
v_add_f32 v9, v9, v93
v_add_f32 v9, v9, v94
v_cvt_pk_bf16_f32 v118, v92, v93
v_mfma_f32_16x16x32_bf16 v[44:47], v[188:191], a[188:191], v[44:47]
v_add_f32 v9, v9, v95
v_cvt_pk_bf16_f32 v119, v94, v95
v_add_f32 v68, v8, v9
v_cmp_nge_f32 vcc, s45, v68
s_cbranch_vccnz L_slow_a_27
L_ret_a_28:
v_mfma_f32_16x16x32_bf16 a[0:3], v[224:227], v[112:115], a[0:3]
v_exp_f32 v96, v32
v_mfma_f32_16x16x32_bf16 a[32:35], v[224:227], v[116:119], a[32:35]
v_exp_f32 v97, v33
v_mfma_f32_16x16x32_bf16 a[4:7], v[228:231], v[112:115], a[4:7]
v_mfma_f32_16x16x32_bf16 a[36:39], v[228:231], v[116:119], a[36:39]
v_mfma_f32_16x16x32_bf16 a[8:11], v[232:235], v[112:115], a[8:11]
v_exp_f32 v98, v34
v_mfma_f32_16x16x32_bf16 a[40:43], v[232:235], v[116:119], a[40:43]
v_exp_f32 v99, v35
v_mfma_f32_16x16x32_bf16 a[12:15], v[236:239], v[112:115], a[12:15]
v_add_f32 v64, v64, v8
v_add_f32 v65, v65, v9
v_add_f32 v10, v96, v97
v_mfma_f32_16x16x32_bf16 a[44:47], v[236:239], v[116:119], a[44:47]
v_mfma_f32_16x16x32_bf16 a[16:19], v[240:243], v[112:115], a[16:19]
v_exp_f32 v100, v36
v_mfma_f32_16x16x32_bf16 a[48:51], v[240:243], v[116:119], a[48:51]
v_exp_f32 v101, v37
v_mfma_f32_16x16x32_bf16 a[20:23], v[244:247], v[112:115], a[20:23]
v_add_f32 v10, v10, v98
v_add_f32 v10, v10, v99
v_cvt_pk_bf16_f32 v120, v96, v97
v_mfma_f32_16x16x32_bf16 a[52:55], v[244:247], v[116:119], a[52:55]
v_mfma_f32_16x16x32_bf16 a[24:27], v[248:251], v[112:115], a[24:27]
s_waitcnt vmcnt(0)
v_exp_f32 v102, v38
v_mfma_f32_16x16x32_bf16 a[56:59], v[248:251], v[116:119], a[56:59]
v_exp_f32 v103, v39
v_mfma_f32_16x16x32_bf16 a[28:31], v[252:255], v[112:115], a[28:31]
v_add_f32 v10, v10, v100
v_add_f32 v10, v10, v101
v_cvt_pk_bf16_f32 v121, v98, v99
v_mfma_f32_16x16x32_bf16 a[60:63], v[252:255], v[116:119], a[60:63]
v_exp_f32 v104, v40
v_exp_f32 v105, v41
s_nop 0
v_add_f32 v10, v10, v102
v_add_f32 v10, v10, v103
v_cvt_pk_bf16_f32 v122, v100, v101
v_exp_f32 v106, v42
v_exp_f32 v107, v43
s_nop 0
v_add_f32 v11, v104, v105
v_cvt_pk_bf16_f32 v123, v102, v103
v_cvt_pk_bf16_f32 v124, v104, v105
v_exp_f32 v108, v44
v_exp_f32 v109, v45
s_nop 0
v_add_f32 v11, v11, v106
v_add_f32 v11, v11, v107
v_cvt_pk_bf16_f32 v125, v106, v107
v_exp_f32 v110, v46
v_exp_f32 v111, v47
s_nop 0
v_add_f32 v11, v11, v108
v_add_f32 v11, v11, v109
v_add_f32 v11, v11, v110
v_cvt_pk_bf16_f32 v126, v108, v109
v_add_f32 v11, v11, v111
v_cvt_pk_bf16_f32 v127, v110, v111
v_add_f32 v68, v10, v11
v_cmp_nge_f32 vcc, s45, v68
s_cbranch_vccnz L_slow_b_29
L_ret_b_30:
v_mfma_f32_16x16x32_bf16 a[64:67], v[224:227], v[120:123], a[64:67]
v_mfma_f32_16x16x32_bf16 a[96:99], v[224:227], v[124:127], a[96:99]
v_mfma_f32_16x16x32_bf16 a[68:71], v[228:231], v[120:123], a[68:71]
v_mfma_f32_16x16x32_bf16 a[100:103], v[228:231], v[124:127], a[100:103]
v_mfma_f32_16x16x32_bf16 a[72:75], v[232:235], v[120:123], a[72:75]
v_mfma_f32_16x16x32_bf16 a[104:107], v[232:235], v[124:127], a[104:107]
v_mfma_f32_16x16x32_bf16 a[76:79], v[236:239], v[120:123], a[76:79]
v_add_f32 v66, v66, v10
v_add_f32 v67, v67, v11
v_mfma_f32_16x16x32_bf16 a[108:111], v[236:239], v[124:127], a[108:111]
v_mfma_f32_16x16x32_bf16 a[80:83], v[240:243], v[120:123], a[80:83]
v_mfma_f32_16x16x32_bf16 a[112:115], v[240:243], v[124:127], a[112:115]
v_mfma_f32_16x16x32_bf16 a[84:87], v[244:247], v[120:123], a[84:87]
v_mfma_f32_16x16x32_bf16 a[116:119], v[244:247], v[124:127], a[116:119]
v_mfma_f32_16x16x32_bf16 a[88:91], v[248:251], v[120:123], a[88:91]
v_mfma_f32_16x16x32_bf16 a[120:123], v[248:251], v[124:127], a[120:123]
v_mfma_f32_16x16x32_bf16 a[92:95], v[252:255], v[120:123], a[92:95]
v_mfma_f32_16x16x32_bf16 a[124:127], v[252:255], v[124:127], a[124:127]
v_mov_b32 v16, v64
v_mov_b32 v17, v65
v_mov_b32 v18, v66
v_mov_b32 v19, v67
v_permlane16_swap_b32 v64, v16
v_permlane16_swap_b32 v65, v17
v_permlane16_swap_b32 v66, v18
v_permlane16_swap_b32 v67, v19
v_add_f32 v64, v64, v16
v_add_f32 v65, v65, v17
v_add_f32 v66, v66, v18
v_add_f32 v67, v67, v19
v_mov_b32 v16, v64
v_mov_b32 v17, v65
v_mov_b32 v18, v66
v_mov_b32 v19, v67
v_permlane32_swap_b32 v64, v16
v_permlane32_swap_b32 v65, v17
v_permlane32_swap_b32 v66, v18
v_permlane32_swap_b32 v67, v19
v_add_f32 v64, v64, v16
v_add_f32 v65, v65, v17
v_add_f32 v66, v66, v18
v_add_f32 v67, v67, v19
v_mov_b32 v49, v64
v_mov_b32 v53, v65
v_mov_b32 v57, v66
v_mov_b32 v61, v67
s_lshl_b32 s36, s34, 11
s_add_u32 s36, s36, 42240
v_lshlrev_b32 v44, 3, v5
v_add_u32 v45, s36, v44
ds_write_b64 v45, v[48:49] offset:0
ds_write_b64 v45, v[52:53] offset:512
ds_write_b64 v45, v[56:57] offset:1024
ds_write_b64 v45, v[60:61] offset:1536
s_cmp_eq_u32 s34, 0
s_cbranch_scc1 L_skipw_33
s_sub_u32 s36, s34, 1
s_and_b32 s36, s36, 3
s_lshl_b32 s36, s36, 13
s_add_u32 s36, s36, 50432
v_add_u32 v45, s36, v1
ds_write_b128 v45, a[0:3] offset:0
ds_write_b128 v45, a[4:7] offset:1024
ds_write_b128 v45, a[8:11] offset:2048
ds_write_b128 v45, a[12:15] offset:3072
ds_write_b128 v45, a[16:19] offset:4096
ds_write_b128 v45, a[20:23] offset:5120
ds_write_b128 v45, a[24:27] offset:6144
ds_write_b128 v45, a[28:31] offset:7168
L_skipw_33:
s_cmp_eq_u32 s34, 1
s_cbranch_scc1 L_skipw_34
s_sub_u32 s36, s34, 2
s_and_b32 s36, s36, 3
s_lshl_b32 s36, s36, 13
s_add_u32 s36, s36, 75008
v_add_u32 v45, s36, v1
ds_write_b128 v45, a[32:35] offset:0
ds_write_b128 v45, a[36:39] offset:1024
ds_write_b128 v45, a[40:43] offset:2048
ds_write_b128 v45, a[44:47] offset:3072
ds_write_b128 v45, a[48:51] offset:4096
ds_write_b128 v45, a[52:55] offset:5120
ds_write_b128 v45, a[56:59] offset:6144
ds_write_b128 v45, a[60:63] offset:7168
L_skipw_34:
s_cmp_eq_u32 s34, 2
s_cbranch_scc1 L_skipw_35
s_sub_u32 s36, s34, 3
s_and_b32 s36, s36, 3
s_lshl_b32 s36, s36, 13
s_add_u32 s36, s36, 99584
v_add_u32 v45, s36, v1
ds_write_b128 v45, a[64:67] offset:0
ds_write_b128 v45, a[68:71] offset:1024
ds_write_b128 v45, a[72:75] offset:2048
ds_write_b128 v45, a[76:79] offset:3072
ds_write_b128 v45, a[80:83] offset:4096
ds_write_b128 v45, a[84:87] offset:5120
ds_write_b128 v45, a[88:91] offset:6144
ds_write_b128 v45, a[92:95] offset:7168
L_skipw_35:
s_cmp_eq_u32 s34, 3
s_cbranch_scc1 L_skipw_36
s_sub_u32 s36, s34, 4
s_and_b32 s36, s36, 3
s_lshl_b32 s36, s36, 13
s_add_u32 s36, s36, 124160
v_add_u32 v45, s36, v1
ds_write_b128 v45, a[96:99] offset:0
ds_write_b128 v45, a[100:103] offset:1024
ds_write_b128 v45, a[104:107] offset:2048
ds_write_b128 v45, a[108:111] offset:3072
ds_write_b128 v45, a[112:115] offset:4096
ds_write_b128 v45, a[116:119] offset:5120
ds_write_b128 v45, a[120:123] offset:6144
ds_write_b128 v45, a[124:127] offset:7168
L_skipw_36:
s_cmp_lg_u32 s34, 0
s_cbranch_scc1 L_ownn_38
v_accvgpr_read_b32 v128, a0
v_accvgpr_read_b32 v129, a1
v_accvgpr_read_b32 v130, a2
v_accvgpr_read_b32 v131, a3
v_accvgpr_read_b32 v132, a4
v_accvgpr_read_b32 v133, a5
v_accvgpr_read_b32 v134, a6
v_accvgpr_read_b32 v135, a7
v_accvgpr_read_b32 v136, a8
v_accvgpr_read_b32 v137, a9
v_accvgpr_read_b32 v138, a10
v_accvgpr_read_b32 v139, a11
v_accvgpr_read_b32 v140, a12
v_accvgpr_read_b32 v141, a13
v_accvgpr_read_b32 v142, a14
v_accvgpr_read_b32 v143, a15
v_accvgpr_read_b32 v144, a16
v_accvgpr_read_b32 v145, a17
v_accvgpr_read_b32 v146, a18
v_accvgpr_read_b32 v147, a19
v_accvgpr_read_b32 v148, a20
v_accvgpr_read_b32 v149, a21
v_accvgpr_read_b32 v150, a22
v_accvgpr_read_b32 v151, a23
v_accvgpr_read_b32 v152, a24
v_accvgpr_read_b32 v153, a25
v_accvgpr_read_b32 v154, a26
v_accvgpr_read_b32 v155, a27
v_accvgpr_read_b32 v156, a28
v_accvgpr_read_b32 v157, a29
v_accvgpr_read_b32 v158, a30
v_accvgpr_read_b32 v159, a31
s_branch L_own_37
L_ownn_38:
s_cmp_lg_u32 s34, 1
s_cbranch_scc1 L_ownn_39
v_accvgpr_read_b32 v128, a32
v_accvgpr_read_b32 v129, a33
v_accvgpr_read_b32 v130, a34
v_accvgpr_read_b32 v131, a35
v_accvgpr_read_b32 v132, a36
v_accvgpr_read_b32 v133, a37
v_accvgpr_read_b32 v134, a38
v_accvgpr_read_b32 v135, a39
v_accvgpr_read_b32 v136, a40
v_accvgpr_read_b32 v137, a41
v_accvgpr_read_b32 v138, a42
v_accvgpr_read_b32 v139, a43
v_accvgpr_read_b32 v140, a44
v_accvgpr_read_b32 v141, a45
v_accvgpr_read_b32 v142, a46
v_accvgpr_read_b32 v143, a47
v_accvgpr_read_b32 v144, a48
v_accvgpr_read_b32 v145, a49
v_accvgpr_read_b32 v146, a50
v_accvgpr_read_b32 v147, a51
v_accvgpr_read_b32 v148, a52
v_accvgpr_read_b32 v149, a53
v_accvgpr_read_b32 v150, a54
v_accvgpr_read_b32 v151, a55
v_accvgpr_read_b32 v152, a56
v_accvgpr_read_b32 v153, a57
v_accvgpr_read_b32 v154, a58
v_accvgpr_read_b32 v155, a59
v_accvgpr_read_b32 v156, a60
v_accvgpr_read_b32 v157, a61
v_accvgpr_read_b32 v158, a62
v_accvgpr_read_b32 v159, a63
s_branch L_own_37
L_ownn_39:
s_cmp_lg_u32 s34, 2
s_cbranch_scc1 L_ownn_40
v_accvgpr_read_b32 v128, a64
v_accvgpr_read_b32 v129, a65
v_accvgpr_read_b32 v130, a66
v_accvgpr_read_b32 v131, a67
v_accvgpr_read_b32 v132, a68
v_accvgpr_read_b32 v133, a69
v_accvgpr_read_b32 v134, a70
v_accvgpr_read_b32 v135, a71
v_accvgpr_read_b32 v136, a72
v_accvgpr_read_b32 v137, a73
v_accvgpr_read_b32 v138, a74
v_accvgpr_read_b32 v139, a75
v_accvgpr_read_b32 v140, a76
v_accvgpr_read_b32 v141, a77
v_accvgpr_read_b32 v142, a78
v_accvgpr_read_b32 v143, a79
v_accvgpr_read_b32 v144, a80
v_accvgpr_read_b32 v145, a81
v_accvgpr_read_b32 v146, a82
v_accvgpr_read_b32 v147, a83
v_accvgpr_read_b32 v148, a84
v_accvgpr_read_b32 v149, a85
v_accvgpr_read_b32 v150, a86
v_accvgpr_read_b32 v151, a87
v_accvgpr_read_b32 v152, a88
v_accvgpr_read_b32 v153, a89
v_accvgpr_read_b32 v154, a90
v_accvgpr_read_b32 v155, a91
v_accvgpr_read_b32 v156, a92
v_accvgpr_read_b32 v157, a93
v_accvgpr_read_b32 v158, a94
v_accvgpr_read_b32 v159, a95
s_branch L_own_37
L_ownn_40:
v_accvgpr_read_b32 v128, a96
v_accvgpr_read_b32 v129, a97
v_accvgpr_read_b32 v130, a98
v_accvgpr_read_b32 v131, a99
v_accvgpr_read_b32 v132, a100
v_accvgpr_read_b32 v133, a101
v_accvgpr_read_b32 v134, a102
v_accvgpr_read_b32 v135, a103
v_accvgpr_read_b32 v136, a104
v_accvgpr_read_b32 v137, a105
v_accvgpr_read_b32 v138, a106
v_accvgpr_read_b32 v139, a107
v_accvgpr_read_b32 v140, a108
v_accvgpr_read_b32 v141, a109
v_accvgpr_read_b32 v142, a110
v_accvgpr_read_b32 v143, a111
v_accvgpr_read_b32 v144, a112
v_accvgpr_read_b32 v145, a113
v_accvgpr_read_b32 v146, a114
v_accvgpr_read_b32 v147, a115
v_accvgpr_read_b32 v148, a116
v_accvgpr_read_b32 v149, a117
v_accvgpr_read_b32 v150, a118
v_accvgpr_read_b32 v151, a119
v_accvgpr_read_b32 v152, a120
v_accvgpr_read_b32 v153, a121
v_accvgpr_read_b32 v154, a122
v_accvgpr_read_b32 v155, a123
v_accvgpr_read_b32 v156, a124
v_accvgpr_read_b32 v157, a125
v_accvgpr_read_b32 v158, a126
v_accvgpr_read_b32 v159, a127
L_own_37:
s_waitcnt lgkmcnt(0)
s_barrier
s_lshl_b32 s37, s34, 9
s_add_u32 s37, s37, 42240
s_add_u32 s36, s34, 0
s_and_b32 s36, s36, 3
s_lshl_b32 s36, s36, 11
s_add_u32 s36, s36, s37
v_add_u32 v45, s36, v44
ds_read_b64 v[16:17], v45
s_add_u32 s36, s34, 1
s_and_b32 s36, s36, 3
s_lshl_b32 s36, s36, 11
s_add_u32 s36, s36, s37
v_add_u32 v45, s36, v44
ds_read_b64 v[18:19], v45
s_add_u32 s36, s34, 2
s_and_b32 s36, s36, 3
s_lshl_b32 s36, s36, 11
s_add_u32 s36, s36, s37
v_add_u32 v45, s36, v44
ds_read_b64 v[20:21], v45
s_add_u32 s36, s34, 3
s_and_b32 s36, s36, 3
s_lshl_b32 s36, s36, 11
s_add_u32 s36, s36, s37
v_add_u32 v45, s36, v44
ds_read_b64 v[22:23], v45
s_mul_i32 s36, s34, 24576
s_add_u32 s36, s36, 50432
v_add_u32 v45, s36, v1
ds_read_b128 v[160:163], v45 offset:0
ds_read_b128 v[192:195], v45 offset:8192
ds_read_b128 v[224:227], v45 offset:16384
ds_read_b128 v[164:167], v45 offset:1024
ds_read_b128 v[196:199], v45 offset:9216
ds_read_b128 v[228:231], v45 offset:17408
ds_read_b128 v[168:171], v45 offset:2048
ds_read_b128 v[200:203], v45 offset:10240
ds_read_b128 v[232:235], v45 offset:18432
s_waitcnt lgkmcnt(9)
v_min3_f32 v40, v16, v18, v20
v_min_f32 v40, v40, v22
v_sub_f32 v32, v40, v16
v_sub_f32 v33, v40, v18
v_sub_f32 v34, v40, v20
v_sub_f32 v35, v40, v22
v_exp_f32 v32, v32
v_exp_f32 v33, v33
v_exp_f32 v34, v34
v_exp_f32 v35, v35
s_nop 0
v_mul_f32 v41, v32, v17
v_fmac_f32 v41, v33, v19
v_fmac_f32 v41, v34, v21
v_fmac_f32 v41, v35, v23
v_rcp_f32 v41, v41
s_nop 0
v_mul_f32 v32, v32, v41
v_mul_f32 v33, v33, v41
v_mul_f32 v34, v34, v41
v_mul_f32 v35, v35, v41
s_lshl_b32 s36, s32, 19
s_lshl_b32 s37, s33, 14
s_add_u32 s36, s36, s37
s_lshl_b32 s37, s34, 12
s_add_u32 s36, s36, s37
v_and_b32 v42, 15, v5
v_lshrrev_b32 v43, 4, v5
v_lshlrev_b32 v42, 8, v42
v_lshl_add_u32 v42, v43, 5, v42
v_add_u32 v42, s36, v42
ds_read_b128 v[172:175], v45 offset:3072
ds_read_b128 v[204:207], v45 offset:11264
ds_read_b128 v[236:239], v45 offset:19456
s_waitcnt lgkmcnt(9)
v_pk_mul_f32 v[128:129], v[128:129], v[32:33] op_sel_hi:[1,0]
v_pk_fma_f32 v[128:129], v[160:161], v[32:33], v[128:129] op_sel:[0,1,0] op_sel_hi:[1,1,1]
v_pk_fma_f32 v[128:129], v[192:193], v[34:35], v[128:129] op_sel:[0,0,0] op_sel_hi:[1,0,1]
v_pk_fma_f32 v[128:129], v[224:225], v[34:35], v[128:129] op_sel:[0,1,0] op_sel_hi:[1,1,1]
v_pk_mul_f32 v[130:131], v[130:131], v[32:33] op_sel_hi:[1,0]
v_pk_fma_f32 v[130:131], v[162:163], v[32:33], v[130:131] op_sel:[0,1,0] op_sel_hi:[1,1,1]
v_pk_fma_f32 v[130:131], v[194:195], v[34:35], v[130:131] op_sel:[0,0,0] op_sel_hi:[1,0,1]
v_pk_fma_f32 v[130:131], v[226:227], v[34:35], v[130:131] op_sel:[0,1,0] op_sel_hi:[1,1,1]
ds_read_b128 v[176:179], v45 offset:4096
ds_read_b128 v[208:211], v45 offset:12288
ds_read_b128 v[240:243], v45 offset:20480
s_waitcnt lgkmcnt(9)
v_pk_mul_f32 v[132:133], v[132:133], v[32:33] op_sel_hi:[1,0]
v_pk_fma_f32 v[132:133], v[164:165], v[32:33], v[132:133] op_sel:[0,1,0] op_sel_hi:[1,1,1]
v_pk_fma_f32 v[132:133], v[196:197], v[34:35], v[132:133] op_sel:[0,0,0] op_sel_hi:[1,0,1]
v_pk_fma_f32 v[132:133], v[228:229], v[34:35], v[132:133] op_sel:[0,1,0] op_sel_hi:[1,1,1]
v_pk_mul_f32 v[134:135], v[134:135], v[32:33] op_sel_hi:[1,0]
v_pk_fma_f32 v[134:135], v[166:167], v[32:33], v[134:135] op_sel:[0,1,0] op_sel_hi:[1,1,1]
v_pk_fma_f32 v[134:135], v[198:199], v[34:35], v[134:135] op_sel:[0,0,0] op_sel_hi:[1,0,1]
v_pk_fma_f32 v[134:135], v[230:231], v[34:35], v[134:135] op_sel:[0,1,0] op_sel_hi:[1,1,1]
ds_read_b128 v[180:183], v45 offset:5120
ds_read_b128 v[212:215], v45 offset:13312
ds_read_b128 v[244:247], v45 offset:21504
s_waitcnt lgkmcnt(9)
v_pk_mul_f32 v[136:137], v[136:137], v[32:33] op_sel_hi:[1,0]
v_pk_fma_f32 v[136:137], v[168:169], v[32:33], v[136:137] op_sel:[0,1,0] op_sel_hi:[1,1,1]
v_pk_fma_f32 v[136:137], v[200:201], v[34:35], v[136:137] op_sel:[0,0,0] op_sel_hi:[1,0,1]
v_pk_fma_f32 v[136:137], v[232:233], v[34:35], v[136:137] op_sel:[0,1,0] op_sel_hi:[1,1,1]
v_pk_mul_f32 v[138:139], v[138:139], v[32:33] op_sel_hi:[1,0]
v_pk_fma_f32 v[138:139], v[170:171], v[32:33], v[138:139] op_sel:[0,1,0] op_sel_hi:[1,1,1]
v_pk_fma_f32 v[138:139], v[202:203], v[34:35], v[138:139] op_sel:[0,0,0] op_sel_hi:[1,0,1]
v_pk_fma_f32 v[138:139], v[234:235], v[34:35], v[138:139] op_sel:[0,1,0] op_sel_hi:[1,1,1]
ds_read_b128 v[184:187], v45 offset:6144
ds_read_b128 v[216:219], v45 offset:14336
ds_read_b128 v[248:251], v45 offset:22528
s_waitcnt lgkmcnt(9)
v_pk_mul_f32 v[140:141], v[140:141], v[32:33] op_sel_hi:[1,0]
v_pk_fma_f32 v[140:141], v[172:173], v[32:33], v[140:141] op_sel:[0,1,0] op_sel_hi:[1,1,1]
v_pk_fma_f32 v[140:141], v[204:205], v[34:35], v[140:141] op_sel:[0,0,0] op_sel_hi:[1,0,1]
v_pk_fma_f32 v[140:141], v[236:237], v[34:35], v[140:141] op_sel:[0,1,0] op_sel_hi:[1,1,1]
v_pk_mul_f32 v[142:143], v[142:143], v[32:33] op_sel_hi:[1,0]
v_pk_fma_f32 v[142:143], v[174:175], v[32:33], v[142:143] op_sel:[0,1,0] op_sel_hi:[1,1,1]
v_pk_fma_f32 v[142:143], v[206:207], v[34:35], v[142:143] op_sel:[0,0,0] op_sel_hi:[1,0,1]
v_pk_fma_f32 v[142:143], v[238:239], v[34:35], v[142:143] op_sel:[0,1,0] op_sel_hi:[1,1,1]
v_cvt_pk_bf16_f32 v48, v128, v132
v_cvt_pk_bf16_f32 v49, v136, v140
v_cvt_pk_bf16_f32 v50, v129, v133
v_cvt_pk_bf16_f32 v51, v137, v141
global_store_dwordx4 v42, v[48:51], s[26:27] offset:0
v_cvt_pk_bf16_f32 v52, v130, v134
v_cvt_pk_bf16_f32 v53, v138, v142
v_cvt_pk_bf16_f32 v54, v131, v135
v_cvt_pk_bf16_f32 v55, v139, v143
global_store_dwordx4 v42, v[52:55], s[26:27] offset:16
ds_read_b128 v[188:191], v45 offset:7168
ds_read_b128 v[220:223], v45 offset:15360
ds_read_b128 v[252:255], v45 offset:23552
s_waitcnt lgkmcnt(9)
v_pk_mul_f32 v[144:145], v[144:145], v[32:33] op_sel_hi:[1,0]
v_pk_fma_f32 v[144:145], v[176:177], v[32:33], v[144:145] op_sel:[0,1,0] op_sel_hi:[1,1,1]
v_pk_fma_f32 v[144:145], v[208:209], v[34:35], v[144:145] op_sel:[0,0,0] op_sel_hi:[1,0,1]
v_pk_fma_f32 v[144:145], v[240:241], v[34:35], v[144:145] op_sel:[0,1,0] op_sel_hi:[1,1,1]
v_pk_mul_f32 v[146:147], v[146:147], v[32:33] op_sel_hi:[1,0]
v_pk_fma_f32 v[146:147], v[178:179], v[32:33], v[146:147] op_sel:[0,1,0] op_sel_hi:[1,1,1]
v_pk_fma_f32 v[146:147], v[210:211], v[34:35], v[146:147] op_sel:[0,0,0] op_sel_hi:[1,0,1]
v_pk_fma_f32 v[146:147], v[242:243], v[34:35], v[146:147] op_sel:[0,1,0] op_sel_hi:[1,1,1]
s_waitcnt lgkmcnt(6)
v_pk_mul_f32 v[148:149], v[148:149], v[32:33] op_sel_hi:[1,0]
v_pk_fma_f32 v[148:149], v[180:181], v[32:33], v[148:149] op_sel:[0,1,0] op_sel_hi:[1,1,1]
v_pk_fma_f32 v[148:149], v[212:213], v[34:35], v[148:149] op_sel:[0,0,0] op_sel_hi:[1,0,1]
v_pk_fma_f32 v[148:149], v[244:245], v[34:35], v[148:149] op_sel:[0,1,0] op_sel_hi:[1,1,1]
v_pk_mul_f32 v[150:151], v[150:151], v[32:33] op_sel_hi:[1,0]
v_pk_fma_f32 v[150:151], v[182:183], v[32:33], v[150:151] op_sel:[0,1,0] op_sel_hi:[1,1,1]
v_pk_fma_f32 v[150:151], v[214:215], v[34:35], v[150:151] op_sel:[0,0,0] op_sel_hi:[1,0,1]
v_pk_fma_f32 v[150:151], v[246:247], v[34:35], v[150:151] op_sel:[0,1,0] op_sel_hi:[1,1,1]
s_waitcnt lgkmcnt(3)
v_pk_mul_f32 v[152:153], v[152:153], v[32:33] op_sel_hi:[1,0]
v_pk_fma_f32 v[152:153], v[184:185], v[32:33], v[152:153] op_sel:[0,1,0] op_sel_hi:[1,1,1]
v_pk_fma_f32 v[152:153], v[216:217], v[34:35], v[152:153] op_sel:[0,0,0] op_sel_hi:[1,0,1]
v_pk_fma_f32 v[152:153], v[248:249], v[34:35], v[152:153] op_sel:[0,1,0] op_sel_hi:[1,1,1]
v_pk_mul_f32 v[154:155], v[154:155], v[32:33] op_sel_hi:[1,0]
v_pk_fma_f32 v[154:155], v[186:187], v[32:33], v[154:155] op_sel:[0,1,0] op_sel_hi:[1,1,1]
v_pk_fma_f32 v[154:155], v[218:219], v[34:35], v[154:155] op_sel:[0,0,0] op_sel_hi:[1,0,1]
v_pk_fma_f32 v[154:155], v[250:251], v[34:35], v[154:155] op_sel:[0,1,0] op_sel_hi:[1,1,1]
s_waitcnt lgkmcnt(0)
v_pk_mul_f32 v[156:157], v[156:157], v[32:33] op_sel_hi:[1,0]
v_pk_fma_f32 v[156:157], v[188:189], v[32:33], v[156:157] op_sel:[0,1,0] op_sel_hi:[1,1,1]
v_pk_fma_f32 v[156:157], v[220:221], v[34:35], v[156:157] op_sel:[0,0,0] op_sel_hi:[1,0,1]
v_pk_fma_f32 v[156:157], v[252:253], v[34:35], v[156:157] op_sel:[0,1,0] op_sel_hi:[1,1,1]
v_pk_mul_f32 v[158:159], v[158:159], v[32:33] op_sel_hi:[1,0]
v_pk_fma_f32 v[158:159], v[190:191], v[32:33], v[158:159] op_sel:[0,1,0] op_sel_hi:[1,1,1]
v_pk_fma_f32 v[158:159], v[222:223], v[34:35], v[158:159] op_sel:[0,0,0] op_sel_hi:[1,0,1]
v_pk_fma_f32 v[158:159], v[254:255], v[34:35], v[158:159] op_sel:[0,1,0] op_sel_hi:[1,1,1]
v_cvt_pk_bf16_f32 v56, v144, v148
v_cvt_pk_bf16_f32 v57, v152, v156
v_cvt_pk_bf16_f32 v58, v145, v149
v_cvt_pk_bf16_f32 v59, v153, v157
global_store_dwordx4 v42, v[56:59], s[26:27] offset:128
v_cvt_pk_bf16_f32 v60, v146, v150
v_cvt_pk_bf16_f32 v61, v154, v158
v_cvt_pk_bf16_f32 v62, v147, v151
v_cvt_pk_bf16_f32 v63, v155, v159
global_store_dwordx4 v42, v[60:63], s[26:27] offset:144
s_cmp_lg_u32 s2, 0
s_cbranch_scc1 L_noep
s_cmp_lg_u32 s34, 0
s_cbranch_scc1 L_noep
v_mov_b32 v1, 9437184
v_mov_b32 v2, s35
s_mov_b64 exec, 1
global_store_dword v1, v2, s[30:31] sc1
s_mov_b64 exec, -1
L_noep:
L_end:
s_endpgm
L_slow_b_13:
s_call_b64 s[66:67], L_sub_b
s_branch L_ret_b_14
L_slow_a_15:
s_call_b64 s[66:67], L_sub_a
s_branch L_ret_a_16
L_slow_b_17:
s_call_b64 s[66:67], L_sub_b
s_branch L_ret_b_18
L_slow_a_19:
s_call_b64 s[66:67], L_sub_a
s_branch L_ret_a_20
L_slow_b_25:
s_call_b64 s[66:67], L_sub_b
s_branch L_ret_b_26
L_slow_a_27:
s_call_b64 s[66:67], L_sub_a
s_branch L_ret_a_28
L_slow_b_29:
s_call_b64 s[66:67], L_sub_b
s_branch L_ret_b_30
L_ktask1b:
v_cvt_f32_i32 v16, v80
v_cvt_f32_i32 v17, v81
v_cvt_f32_i32 v18, v82
v_cvt_f32_i32 v19, v83
v_cvt_f32_i32 v20, v84
v_cvt_f32_i32 v21, v85
v_cvt_f32_i32 v22, v86
v_cvt_f32_i32 v23, v87
v_cvt_f32_i32 v24, v88
v_cvt_f32_i32 v25, v89
v_cvt_f32_i32 v26, v90
v_cvt_f32_i32 v27, v91
v_cvt_f32_i32 v28, v92
v_cvt_f32_i32 v29, v93
v_cvt_f32_i32 v30, v94
v_cvt_f32_i32 v31, v95
s_mov_b32 s39, s1
v_mov_b32 v40, v42
v_mov_b32 v41, v43
s_branch L_kbody
L_ktask1:
s_mov_b32 s39, s1
v_mov_b32 v40, v42
v_mov_b32 v41, v43
s_branch L_kcvt
L_ktask0:
s_mov_b32 s39, s29
L_kcvt:
v_cvt_f32_i32 v16, v16
v_cvt_f32_i32 v17, v17
v_cvt_f32_i32 v18, v18
v_cvt_f32_i32 v19, v19
v_cvt_f32_i32 v20, v20
v_cvt_f32_i32 v21, v21
v_cvt_f32_i32 v22, v22
v_cvt_f32_i32 v23, v23
v_cvt_f32_i32 v24, v24
v_cvt_f32_i32 v25, v25
v_cvt_f32_i32 v26, v26
v_cvt_f32_i32 v27, v27
v_cvt_f32_i32 v28, v28
v_cvt_f32_i32 v29, v29
v_cvt_f32_i32 v30, v30
v_cvt_f32_i32 v31, v31
L_kbody:
v_max3_f32 v176, |v16|, |v17|, 0
v_max3_f32 v176, |v18|, |v19|, v176
v_max3_f32 v176, |v20|, |v21|, v176
v_max3_f32 v176, |v22|, |v23|, v176
v_max3_f32 v176, |v24|, |v25|, v176
v_max3_f32 v176, |v26|, |v27|, v176
v_max3_f32 v176, |v28|, |v29|, v176
v_max3_f32 v176, |v30|, |v31|, v176
v_cmp_lt_f32 vcc, 0x43800000, v176
s_cbranch_vccnz L_big_42
L_bigret_43:
v_pk_fma_f32 v[16:17], v[16:17], v[40:41], v[40:41] op_sel:[0,0,1] op_sel_hi:[1,0,1] neg_lo:[0,0,1] neg_hi:[0,0,1]
v_pk_fma_f32 v[18:19], v[18:19], v[40:41], v[40:41] op_sel:[0,0,1] op_sel_hi:[1,0,1] neg_lo:[0,0,1] neg_hi:[0,0,1]
v_pk_fma_f32 v[20:21], v[20:21], v[40:41], v[40:41] op_sel:[0,0,1] op_sel_hi:[1,0,1] neg_lo:[0,0,1] neg_hi:[0,0,1]
v_pk_fma_f32 v[22:23], v[22:23], v[40:41], v[40:41] op_sel:[0,0,1] op_sel_hi:[1,0,1] neg_lo:[0,0,1] neg_hi:[0,0,1]
v_pk_fma_f32 v[24:25], v[24:25], v[40:41], v[40:41] op_sel:[0,0,1] op_sel_hi:[1,0,1] neg_lo:[0,0,1] neg_hi:[0,0,1]
v_pk_fma_f32 v[26:27], v[26:27], v[40:41], v[40:41] op_sel:[0,0,1] op_sel_hi:[1,0,1] neg_lo:[0,0,1] neg_hi:[0,0,1]
v_pk_fma_f32 v[28:29], v[28:29], v[40:41], v[40:41] op_sel:[0,0,1] op_sel_hi:[1,0,1] neg_lo:[0,0,1] neg_hi:[0,0,1]
v_pk_fma_f32 v[30:31], v[30:31], v[40:41], v[40:41] op_sel:[0,0,1] op_sel_hi:[1,0,1] neg_lo:[0,0,1] neg_hi:[0,0,1]
v_pk_mul_f32 v[176:177], v[16:17], v[192:193]
v_pk_mul_f32 v[178:179], v[24:25], v[194:195]
v_pk_fma_f32 v[176:177], v[24:25], v[196:197], v[176:177] neg_lo:[1,0,0] neg_hi:[1,0,0]
v_pk_fma_f32 v[178:179], v[16:17], v[198:199], v[178:179]
v_cvt_pk_bf16_f32 v180, v176, v177
v_cvt_pk_bf16_f32 v184, v178, v179
v_pk_mul_f32 v[176:177], v[18:19], v[200:201]
v_pk_mul_f32 v[178:179], v[26:27], v[202:203]
v_pk_fma_f32 v[176:177], v[26:27], v[204:205], v[176:177] neg_lo:[1,0,0] neg_hi:[1,0,0]
v_pk_fma_f32 v[178:179], v[18:19], v[206:207], v[178:179]
v_cvt_pk_bf16_f32 v181, v176, v177
v_cvt_pk_bf16_f32 v185, v178, v179
v_pk_mul_f32 v[176:177], v[20:21], v[208:209]
v_pk_mul_f32 v[178:179], v[28:29], v[210:211]
v_pk_fma_f32 v[176:177], v[28:29], v[212:213], v[176:177] neg_lo:[1,0,0] neg_hi:[1,0,0]
v_pk_fma_f32 v[178:179], v[20:21], v[214:215], v[178:179]
v_cvt_pk_bf16_f32 v182, v176, v177
v_cvt_pk_bf16_f32 v186, v178, v179
v_pk_mul_f32 v[176:177], v[22:23], v[216:217]
v_pk_mul_f32 v[178:179], v[30:31], v[218:219]
v_pk_fma_f32 v[176:177], v[30:31], v[220:221], v[176:177] neg_lo:[1,0,0] neg_hi:[1,0,0]
v_pk_fma_f32 v[178:179], v[22:23], v[222:223], v[178:179]
v_cvt_pk_bf16_f32 v183, v176, v177
v_cvt_pk_bf16_f32 v187, v178, v179
ds_write_b128 v36, v[180:183]
ds_write_b128 v36, v[184:187] offset:1152
v_add_u32 v176, s39, v38
s_lshr_b32 s36, s39, 12
s_add_u32 s36, s36, s2
s_lshl_b32 s36, s36, 6
s_add_u32 s36, s36, 8388608
s_waitcnt lgkmcnt(0)
ds_read_b128 v[180:183], v37
ds_read_b128 v[184:187], v37 offset:1152
v_mov_b32 v0, s36
s_waitcnt lgkmcnt(1)
global_store_dwordx4 v176, v[180:183], s[30:31] sc1
s_waitcnt lgkmcnt(0)
global_store_dwordx4 v176, v[184:187], s[30:31] offset:256 sc1
s_setpc_b64 s[66:67]
L_vtask:
v_cvt_f32_i32 v96, v96
v_cvt_f32_i32 v97, v97
v_cvt_f32_i32 v98, v98
v_cvt_f32_i32 v99, v99
v_cvt_f32_i32 v100, v100
v_cvt_f32_i32 v101, v101
v_cvt_f32_i32 v102, v102
v_cvt_f32_i32 v103, v103
v_cvt_f32_i32 v104, v104
v_cvt_f32_i32 v105, v105
v_cvt_f32_i32 v106, v106
v_cvt_f32_i32 v107, v107
v_cvt_f32_i32 v108, v108
v_cvt_f32_i32 v109, v109
v_cvt_f32_i32 v110, v110
v_cvt_f32_i32 v111, v111
v_cvt_f32_i32 v112, v112
v_cvt_f32_i32 v113, v113
v_cvt_f32_i32 v114, v114
v_cvt_f32_i32 v115, v115
v_cvt_f32_i32 v116, v116
v_cvt_f32_i32 v117, v117
v_cvt_f32_i32 v118, v118
v_cvt_f32_i32 v119, v119
v_cvt_f32_i32 v120, v120
v_cvt_f32_i32 v121, v121
v_cvt_f32_i32 v122, v122
v_cvt_f32_i32 v123, v123
v_cvt_f32_i32 v124, v124
v_cvt_f32_i32 v125, v125
v_cvt_f32_i32 v126, v126
v_cvt_f32_i32 v127, v127
v_max3_f32 v176, |v96|, |v97|, 0
v_max3_f32 v176, |v98|, |v99|, v176
v_max3_f32 v176, |v100|, |v101|, v176
v_max3_f32 v176, |v102|, |v103|, v176
v_max3_f32 v176, |v104|, |v105|, v176
v_max3_f32 v176, |v106|, |v107|, v176
v_max3_f32 v176, |v108|, |v109|, v176
v_max3_f32 v176, |v110|, |v111|, v176
v_max3_f32 v176, |v112|, |v113|, v176
v_max3_f32 v176, |v114|, |v115|, v176
v_max3_f32 v176, |v116|, |v117|, v176
v_max3_f32 v176, |v118|, |v119|, v176
v_max3_f32 v176, |v120|, |v121|, v176
v_max3_f32 v176, |v122|, |v123|, v176
v_max3_f32 v176, |v124|, |v125|, v176
v_max3_f32 v176, |v126|, |v127|, v176
v_cmp_lt_f32 vcc, 0x43800000, v176
s_cbranch_vccnz L_big_44
L_bigret_45:
v_pk_fma_f32 v[96:97], v[96:97], v[64:65], v[72:73] op_sel:[0,0,0] op_sel_hi:[1,0,0] neg_lo:[0,0,1] neg_hi:[0,0,1]
v_pk_fma_f32 v[98:99], v[98:99], v[64:65], v[72:73] op_sel:[0,0,0] op_sel_hi:[1,0,0] neg_lo:[0,0,1] neg_hi:[0,0,1]
v_pk_fma_f32 v[100:101], v[100:101], v[64:65], v[72:73] op_sel:[0,1,1] op_sel_hi:[1,1,1] neg_lo:[0,0,1] neg_hi:[0,0,1]
v_pk_fma_f32 v[102:103], v[102:103], v[64:65], v[72:73] op_sel:[0,1,1] op_sel_hi:[1,1,1] neg_lo:[0,0,1] neg_hi:[0,0,1]
v_pk_fma_f32 v[104:105], v[104:105], v[66:67], v[74:75] op_sel:[0,0,0] op_sel_hi:[1,0,0] neg_lo:[0,0,1] neg_hi:[0,0,1]
v_pk_fma_f32 v[106:107], v[106:107], v[66:67], v[74:75] op_sel:[0,0,0] op_sel_hi:[1,0,0] neg_lo:[0,0,1] neg_hi:[0,0,1]
v_pk_fma_f32 v[108:109], v[108:109], v[66:67], v[74:75] op_sel:[0,1,1] op_sel_hi:[1,1,1] neg_lo:[0,0,1] neg_hi:[0,0,1]
v_pk_fma_f32 v[110:111], v[110:111], v[66:67], v[74:75] op_sel:[0,1,1] op_sel_hi:[1,1,1] neg_lo:[0,0,1] neg_hi:[0,0,1]
v_pk_fma_f32 v[112:113], v[112:113], v[68:69], v[76:77] op_sel:[0,0,0] op_sel_hi:[1,0,0] neg_lo:[0,0,1] neg_hi:[0,0,1]
v_pk_fma_f32 v[114:115], v[114:115], v[68:69], v[76:77] op_sel:[0,0,0] op_sel_hi:[1,0,0] neg_lo:[0,0,1] neg_hi:[0,0,1]
v_pk_fma_f32 v[116:117], v[116:117], v[68:69], v[76:77] op_sel:[0,1,1] op_sel_hi:[1,1,1] neg_lo:[0,0,1] neg_hi:[0,0,1]
v_pk_fma_f32 v[118:119], v[118:119], v[68:69], v[76:77] op_sel:[0,1,1] op_sel_hi:[1,1,1] neg_lo:[0,0,1] neg_hi:[0,0,1]
v_pk_fma_f32 v[120:121], v[120:121], v[70:71], v[78:79] op_sel:[0,0,0] op_sel_hi:[1,0,0] neg_lo:[0,0,1] neg_hi:[0,0,1]
v_pk_fma_f32 v[122:123], v[122:123], v[70:71], v[78:79] op_sel:[0,0,0] op_sel_hi:[1,0,0] neg_lo:[0,0,1] neg_hi:[0,0,1]
v_pk_fma_f32 v[124:125], v[124:125], v[70:71], v[78:79] op_sel:[0,1,1] op_sel_hi:[1,1,1] neg_lo:[0,0,1] neg_hi:[0,0,1]
v_pk_fma_f32 v[126:127], v[126:127], v[70:71], v[78:79] op_sel:[0,1,1] op_sel_hi:[1,1,1] neg_lo:[0,0,1] neg_hi:[0,0,1]
v_cvt_pk_bf16_f32 v176, v96, v100
v_cvt_pk_bf16_f32 v177, v104, v108
v_cvt_pk_bf16_f32 v178, v112, v116
v_cvt_pk_bf16_f32 v179, v120, v124
global_store_dwordx4 v44, v[176:179], s[30:31] offset:0 sc1
v_cvt_pk_bf16_f32 v180, v97, v101
v_cvt_pk_bf16_f32 v181, v105, v109
v_cvt_pk_bf16_f32 v182, v113, v117
v_cvt_pk_bf16_f32 v183, v121, v125
global_store_dwordx4 v44, v[180:183], s[30:31] offset:1024 sc1
v_cvt_pk_bf16_f32 v184, v98, v102
v_cvt_pk_bf16_f32 v185, v106, v110
v_cvt_pk_bf16_f32 v186, v114, v118
v_cvt_pk_bf16_f32 v187, v122, v126
global_store_dwordx4 v44, v[184:187], s[30:31] offset:2048 sc1
v_cvt_pk_bf16_f32 v188, v99, v103
v_cvt_pk_bf16_f32 v189, v107, v111
v_cvt_pk_bf16_f32 v190, v115, v119
v_cvt_pk_bf16_f32 v191, v123, v127
global_store_dwordx4 v44, v[188:191], s[30:31] offset:3072 sc1
s_lshl_b32 s36, s32, 5
s_add_u32 s36, s36, s33
s_lshl_b32 s36, s36, 2
s_xor_b32 s37, s34, 2
s_add_u32 s36, s36, s37
s_lshl_b32 s36, s36, 6
s_add_u32 s36, s36, 8912896
v_mov_b32 v0, s36
s_setpc_b64 s[66:67]
L_codeend:
L_big_42:
v_cvt_pk_bf16_f32 v17, v16, v17
v_lshlrev_b32 v16, 16, v17
v_and_b32 v17, 0xffff0000, v17
v_cvt_pk_bf16_f32 v19, v18, v19
v_lshlrev_b32 v18, 16, v19
v_and_b32 v19, 0xffff0000, v19
v_cvt_pk_bf16_f32 v21, v20, v21
v_lshlrev_b32 v20, 16, v21
v_and_b32 v21, 0xffff0000, v21
v_cvt_pk_bf16_f32 v23, v22, v23
v_lshlrev_b32 v22, 16, v23
v_and_b32 v23, 0xffff0000, v23
v_cvt_pk_bf16_f32 v25, v24, v25
v_lshlrev_b32 v24, 16, v25
v_and_b32 v25, 0xffff0000, v25
v_cvt_pk_bf16_f32 v27, v26, v27
v_lshlrev_b32 v26, 16, v27
v_and_b32 v27, 0xffff0000, v27
v_cvt_pk_bf16_f32 v29, v28, v29
v_lshlrev_b32 v28, 16, v29
v_and_b32 v29, 0xffff0000, v29
v_cvt_pk_bf16_f32 v31, v30, v31
v_lshlrev_b32 v30, 16, v31
v_and_b32 v31, 0xffff0000, v31
s_branch L_bigret_43
L_big_44:
v_cvt_pk_bf16_f32 v97, v96, v97
v_lshlrev_b32 v96, 16, v97
v_and_b32 v97, 0xffff0000, v97
v_cvt_pk_bf16_f32 v99, v98, v99
v_lshlrev_b32 v98, 16, v99
v_and_b32 v99, 0xffff0000, v99
v_cvt_pk_bf16_f32 v101, v100, v101
v_lshlrev_b32 v100, 16, v101
v_and_b32 v101, 0xffff0000, v101
v_cvt_pk_bf16_f32 v103, v102, v103
v_lshlrev_b32 v102, 16, v103
v_and_b32 v103, 0xffff0000, v103
v_cvt_pk_bf16_f32 v105, v104, v105
v_lshlrev_b32 v104, 16, v105
v_and_b32 v105, 0xffff0000, v105
v_cvt_pk_bf16_f32 v107, v106, v107
v_lshlrev_b32 v106, 16, v107
v_and_b32 v107, 0xffff0000, v107
v_cvt_pk_bf16_f32 v109, v108, v109
v_lshlrev_b32 v108, 16, v109
v_and_b32 v109, 0xffff0000, v109
v_cvt_pk_bf16_f32 v111, v110, v111
v_lshlrev_b32 v110, 16, v111
v_and_b32 v111, 0xffff0000, v111
v_cvt_pk_bf16_f32 v113, v112, v113
v_lshlrev_b32 v112, 16, v113
v_and_b32 v113, 0xffff0000, v113
v_cvt_pk_bf16_f32 v115, v114, v115
v_lshlrev_b32 v114, 16, v115
v_and_b32 v115, 0xffff0000, v115
v_cvt_pk_bf16_f32 v117, v116, v117
v_lshlrev_b32 v116, 16, v117
v_and_b32 v117, 0xffff0000, v117
v_cvt_pk_bf16_f32 v119, v118, v119
v_lshlrev_b32 v118, 16, v119
v_and_b32 v119, 0xffff0000, v119
v_cvt_pk_bf16_f32 v121, v120, v121
v_lshlrev_b32 v120, 16, v121
v_and_b32 v121, 0xffff0000, v121
v_cvt_pk_bf16_f32 v123, v122, v123
v_lshlrev_b32 v122, 16, v123
v_and_b32 v123, 0xffff0000, v123
v_cvt_pk_bf16_f32 v125, v124, v125
v_lshlrev_b32 v124, 16, v125
v_and_b32 v125, 0xffff0000, v125
v_cvt_pk_bf16_f32 v127, v126, v127
v_lshlrev_b32 v126, 16, v127
v_and_b32 v127, 0xffff0000, v127
s_branch L_bigret_45
L_sub_a:
s_nop 7
v_max3_f32 v12, v16, v17, v18
v_max3_f32 v12, v19, v20, v12
v_max3_f32 v12, v21, v22, v12
v_max3_f32 v12, v23, v12, 0
v_mov_b32 v13, v12
s_nop 1
v_permlane16_swap_b32 v12, v13
s_nop 1
v_max_f32 v12, v12, v13
v_mov_b32 v13, v12
s_nop 1
v_permlane32_swap_b32 v12, v13
s_nop 1
v_max_f32 v12, v12, v13
v_exp_f32 v13, -v12
v_sub_f32 v16, v16, v12
v_sub_f32 v17, v17, v12
v_sub_f32 v18, v18, v12
v_sub_f32 v19, v19, v12
v_sub_f32 v20, v20, v12
v_sub_f32 v21, v21, v12
v_sub_f32 v22, v22, v12
v_sub_f32 v23, v23, v12
v_sub_f32 v48, v48, v12
v_sub_f32 v49, v49, v12
v_sub_f32 v50, v50, v12
v_sub_f32 v51, v51, v12
v_mul_f32 v64, v64, v13
v_accvgpr_read_b32 v14, a0
v_mul_f32 v14, v14, v13
v_accvgpr_write_b32 a0, v14
v_accvgpr_read_b32 v14, a1
v_mul_f32 v14, v14, v13
v_accvgpr_write_b32 a1, v14
v_accvgpr_read_b32 v14, a2
v_mul_f32 v14, v14, v13
v_accvgpr_write_b32 a2, v14
v_accvgpr_read_b32 v14, a3
v_mul_f32 v14, v14, v13
v_accvgpr_write_b32 a3, v14
v_accvgpr_read_b32 v14, a4
v_mul_f32 v14, v14, v13
v_accvgpr_write_b32 a4, v14
v_accvgpr_read_b32 v14, a5
v_mul_f32 v14, v14, v13
v_accvgpr_write_b32 a5, v14
v_accvgpr_read_b32 v14, a6
v_mul_f32 v14, v14, v13
v_accvgpr_write_b32 a6, v14
v_accvgpr_read_b32 v14, a7
v_mul_f32 v14, v14, v13
v_accvgpr_write_b32 a7, v14
v_accvgpr_read_b32 v14, a8
v_mul_f32 v14, v14, v13
v_accvgpr_write_b32 a8, v14
v_accvgpr_read_b32 v14, a9
v_mul_f32 v14, v14, v13
v_accvgpr_write_b32 a9, v14
v_accvgpr_read_b32 v14, a10
v_mul_f32 v14, v14, v13
v_accvgpr_write_b32 a10, v14
v_accvgpr_read_b32 v14, a11
v_mul_f32 v14, v14, v13
v_accvgpr_write_b32 a11, v14
v_accvgpr_read_b32 v14, a12
v_mul_f32 v14, v14, v13
v_accvgpr_write_b32 a12, v14
v_accvgpr_read_b32 v14, a13
v_mul_f32 v14, v14, v13
v_accvgpr_write_b32 a13, v14
v_accvgpr_read_b32 v14, a14
v_mul_f32 v14, v14, v13
v_accvgpr_write_b32 a14, v14
v_accvgpr_read_b32 v14, a15
v_mul_f32 v14, v14, v13
v_accvgpr_write_b32 a15, v14
v_accvgpr_read_b32 v14, a16
v_mul_f32 v14, v14, v13
v_accvgpr_write_b32 a16, v14
v_accvgpr_read_b32 v14, a17
v_mul_f32 v14, v14, v13
v_accvgpr_write_b32 a17, v14
v_accvgpr_read_b32 v14, a18
v_mul_f32 v14, v14, v13
v_accvgpr_write_b32 a18, v14
v_accvgpr_read_b32 v14, a19
v_mul_f32 v14, v14, v13
v_accvgpr_write_b32 a19, v14
v_accvgpr_read_b32 v14, a20
v_mul_f32 v14, v14, v13
v_accvgpr_write_b32 a20, v14
v_accvgpr_read_b32 v14, a21
v_mul_f32 v14, v14, v13
v_accvgpr_write_b32 a21, v14
v_accvgpr_read_b32 v14, a22
v_mul_f32 v14, v14, v13
v_accvgpr_write_b32 a22, v14
v_accvgpr_read_b32 v14, a23
v_mul_f32 v14, v14, v13
v_accvgpr_write_b32 a23, v14
v_accvgpr_read_b32 v14, a24
v_mul_f32 v14, v14, v13
v_accvgpr_write_b32 a24, v14
v_accvgpr_read_b32 v14, a25
v_mul_f32 v14, v14, v13
v_accvgpr_write_b32 a25, v14
v_accvgpr_read_b32 v14, a26
v_mul_f32 v14, v14, v13
v_accvgpr_write_b32 a26, v14
v_accvgpr_read_b32 v14, a27
v_mul_f32 v14, v14, v13
v_accvgpr_write_b32 a27, v14
v_accvgpr_read_b32 v14, a28
v_mul_f32 v14, v14, v13
v_accvgpr_write_b32 a28, v14
v_accvgpr_read_b32 v14, a29
v_mul_f32 v14, v14, v13
v_accvgpr_write_b32 a29, v14
v_accvgpr_read_b32 v14, a30
v_mul_f32 v14, v14, v13
v_accvgpr_write_b32 a30, v14
v_accvgpr_read_b32 v14, a31
v_mul_f32 v14, v14, v13
v_accvgpr_write_b32 a31, v14
v_max3_f32 v12, v24, v25, v26
v_max3_f32 v12, v27, v28, v12
v_max3_f32 v12, v29, v30, v12
v_max3_f32 v12, v31, v12, 0
v_mov_b32 v13, v12
s_nop 1
v_permlane16_swap_b32 v12, v13
s_nop 1
v_max_f32 v12, v12, v13
v_mov_b32 v13, v12
s_nop 1
v_permlane32_swap_b32 v12, v13
s_nop 1
v_max_f32 v12, v12, v13
v_exp_f32 v13, -v12
v_sub_f32 v24, v24, v12
v_sub_f32 v25, v25, v12
v_sub_f32 v26, v26, v12
v_sub_f32 v27, v27, v12
v_sub_f32 v28, v28, v12
v_sub_f32 v29, v29, v12
v_sub_f32 v30, v30, v12
v_sub_f32 v31, v31, v12
v_sub_f32 v52, v52, v12
v_sub_f32 v53, v53, v12
v_sub_f32 v54, v54, v12
v_sub_f32 v55, v55, v12
v_mul_f32 v65, v65, v13
v_accvgpr_read_b32 v14, a32
v_mul_f32 v14, v14, v13
v_accvgpr_write_b32 a32, v14
v_accvgpr_read_b32 v14, a33
v_mul_f32 v14, v14, v13
v_accvgpr_write_b32 a33, v14
v_accvgpr_read_b32 v14, a34
v_mul_f32 v14, v14, v13
v_accvgpr_write_b32 a34, v14
v_accvgpr_read_b32 v14, a35
v_mul_f32 v14, v14, v13
v_accvgpr_write_b32 a35, v14
v_accvgpr_read_b32 v14, a36
v_mul_f32 v14, v14, v13
v_accvgpr_write_b32 a36, v14
v_accvgpr_read_b32 v14, a37
v_mul_f32 v14, v14, v13
v_accvgpr_write_b32 a37, v14
v_accvgpr_read_b32 v14, a38
v_mul_f32 v14, v14, v13
v_accvgpr_write_b32 a38, v14
v_accvgpr_read_b32 v14, a39
v_mul_f32 v14, v14, v13
v_accvgpr_write_b32 a39, v14
v_accvgpr_read_b32 v14, a40
v_mul_f32 v14, v14, v13
v_accvgpr_write_b32 a40, v14
v_accvgpr_read_b32 v14, a41
v_mul_f32 v14, v14, v13
v_accvgpr_write_b32 a41, v14
v_accvgpr_read_b32 v14, a42
v_mul_f32 v14, v14, v13
v_accvgpr_write_b32 a42, v14
v_accvgpr_read_b32 v14, a43
v_mul_f32 v14, v14, v13
v_accvgpr_write_b32 a43, v14
v_accvgpr_read_b32 v14, a44
v_mul_f32 v14, v14, v13
v_accvgpr_write_b32 a44, v14
v_accvgpr_read_b32 v14, a45
v_mul_f32 v14, v14, v13
v_accvgpr_write_b32 a45, v14
v_accvgpr_read_b32 v14, a46
v_mul_f32 v14, v14, v13
v_accvgpr_write_b32 a46, v14
v_accvgpr_read_b32 v14, a47
v_mul_f32 v14, v14, v13
v_accvgpr_write_b32 a47, v14
v_accvgpr_read_b32 v14, a48
v_mul_f32 v14, v14, v13
v_accvgpr_write_b32 a48, v14
v_accvgpr_read_b32 v14, a49
v_mul_f32 v14, v14, v13
v_accvgpr_write_b32 a49, v14
v_accvgpr_read_b32 v14, a50
v_mul_f32 v14, v14, v13
v_accvgpr_write_b32 a50, v14
v_accvgpr_read_b32 v14, a51
v_mul_f32 v14, v14, v13
v_accvgpr_write_b32 a51, v14
v_accvgpr_read_b32 v14, a52
v_mul_f32 v14, v14, v13
v_accvgpr_write_b32 a52, v14
v_accvgpr_read_b32 v14, a53
v_mul_f32 v14, v14, v13
v_accvgpr_write_b32 a53, v14
v_accvgpr_read_b32 v14, a54
v_mul_f32 v14, v14, v13
v_accvgpr_write_b32 a54, v14
v_accvgpr_read_b32 v14, a55
v_mul_f32 v14, v14, v13
v_accvgpr_write_b32 a55, v14
v_accvgpr_read_b32 v14, a56
v_mul_f32 v14, v14, v13
v_accvgpr_write_b32 a56, v14
v_accvgpr_read_b32 v14, a57
v_mul_f32 v14, v14, v13
v_accvgpr_write_b32 a57, v14
v_accvgpr_read_b32 v14, a58
v_mul_f32 v14, v14, v13
v_accvgpr_write_b32 a58, v14
v_accvgpr_read_b32 v14, a59
v_mul_f32 v14, v14, v13
v_accvgpr_write_b32 a59, v14
v_accvgpr_read_b32 v14, a60
v_mul_f32 v14, v14, v13
v_accvgpr_write_b32 a60, v14
v_accvgpr_read_b32 v14, a61
v_mul_f32 v14, v14, v13
v_accvgpr_write_b32 a61, v14
v_accvgpr_read_b32 v14, a62
v_mul_f32 v14, v14, v13
v_accvgpr_write_b32 a62, v14
v_accvgpr_read_b32 v14, a63
v_mul_f32 v14, v14, v13
v_accvgpr_write_b32 a63, v14
v_exp_f32 v80, v16
v_exp_f32 v81, v17
v_exp_f32 v82, v18
v_exp_f32 v83, v19
v_exp_f32 v84, v20
v_exp_f32 v85, v21
v_exp_f32 v86, v22
v_exp_f32 v87, v23
v_exp_f32 v88, v24
v_exp_f32 v89, v25
v_exp_f32 v90, v26
v_exp_f32 v91, v27
v_exp_f32 v92, v28
v_exp_f32 v93, v29
v_exp_f32 v94, v30
v_exp_f32 v95, v31
s_nop 0
v_add_f32 v8, v80, v81
v_add_f32 v8, v8, v82
v_add_f32 v8, v8, v83
v_add_f32 v8, v8, v84
v_add_f32 v8, v8, v85
v_add_f32 v8, v8, v86
v_add_f32 v8, v8, v87
v_add_f32 v9, v88, v89
v_add_f32 v9, v9, v90
v_add_f32 v9, v9, v91
v_add_f32 v9, v9, v92
v_add_f32 v9, v9, v93
v_add_f32 v9, v9, v94
v_add_f32 v9, v9, v95
v_cvt_pk_bf16_f32 v112, v80, v81
v_cvt_pk_bf16_f32 v113, v82, v83
v_cvt_pk_bf16_f32 v114, v84, v85
v_cvt_pk_bf16_f32 v115, v86, v87
v_cvt_pk_bf16_f32 v116, v88, v89
v_cvt_pk_bf16_f32 v117, v90, v91
v_cvt_pk_bf16_f32 v118, v92, v93
v_cvt_pk_bf16_f32 v119, v94, v95
s_nop 3
s_setpc_b64 s[66:67]
L_sub_b:
s_nop 7
v_max3_f32 v12, v32, v33, v34
v_max3_f32 v12, v35, v36, v12
v_max3_f32 v12, v37, v38, v12
v_max3_f32 v12, v39, v12, 0
v_mov_b32 v13, v12
s_nop 1
v_permlane16_swap_b32 v12, v13
s_nop 1
v_max_f32 v12, v12, v13
v_mov_b32 v13, v12
s_nop 1
v_permlane32_swap_b32 v12, v13
s_nop 1
v_max_f32 v12, v12, v13
v_exp_f32 v13, -v12
v_sub_f32 v32, v32, v12
v_sub_f32 v33, v33, v12
v_sub_f32 v34, v34, v12
v_sub_f32 v35, v35, v12
v_sub_f32 v36, v36, v12
v_sub_f32 v37, v37, v12
v_sub_f32 v38, v38, v12
v_sub_f32 v39, v39, v12
v_sub_f32 v56, v56, v12
v_sub_f32 v57, v57, v12
v_sub_f32 v58, v58, v12
v_sub_f32 v59, v59, v12
v_mul_f32 v66, v66, v13
v_accvgpr_read_b32 v14, a64
v_mul_f32 v14, v14, v13
v_accvgpr_write_b32 a64, v14
v_accvgpr_read_b32 v14, a65
v_mul_f32 v14, v14, v13
v_accvgpr_write_b32 a65, v14
v_accvgpr_read_b32 v14, a66
v_mul_f32 v14, v14, v13
v_accvgpr_write_b32 a66, v14
v_accvgpr_read_b32 v14, a67
v_mul_f32 v14, v14, v13
v_accvgpr_write_b32 a67, v14
v_accvgpr_read_b32 v14, a68
v_mul_f32 v14, v14, v13
v_accvgpr_write_b32 a68, v14
v_accvgpr_read_b32 v14, a69
v_mul_f32 v14, v14, v13
v_accvgpr_write_b32 a69, v14
v_accvgpr_read_b32 v14, a70
v_mul_f32 v14, v14, v13
v_accvgpr_write_b32 a70, v14
v_accvgpr_read_b32 v14, a71
v_mul_f32 v14, v14, v13
v_accvgpr_write_b32 a71, v14
v_accvgpr_read_b32 v14, a72
v_mul_f32 v14, v14, v13
v_accvgpr_write_b32 a72, v14
v_accvgpr_read_b32 v14, a73
v_mul_f32 v14, v14, v13
v_accvgpr_write_b32 a73, v14
v_accvgpr_read_b32 v14, a74
v_mul_f32 v14, v14, v13
v_accvgpr_write_b32 a74, v14
v_accvgpr_read_b32 v14, a75
v_mul_f32 v14, v14, v13
v_accvgpr_write_b32 a75, v14
v_accvgpr_read_b32 v14, a76
v_mul_f32 v14, v14, v13
v_accvgpr_write_b32 a76, v14
v_accvgpr_read_b32 v14, a77
v_mul_f32 v14, v14, v13
v_accvgpr_write_b32 a77, v14
v_accvgpr_read_b32 v14, a78
v_mul_f32 v14, v14, v13
v_accvgpr_write_b32 a78, v14
v_accvgpr_read_b32 v14, a79
v_mul_f32 v14, v14, v13
v_accvgpr_write_b32 a79, v14
v_accvgpr_read_b32 v14, a80
v_mul_f32 v14, v14, v13
v_accvgpr_write_b32 a80, v14
v_accvgpr_read_b32 v14, a81
v_mul_f32 v14, v14, v13
v_accvgpr_write_b32 a81, v14
v_accvgpr_read_b32 v14, a82
v_mul_f32 v14, v14, v13
v_accvgpr_write_b32 a82, v14
v_accvgpr_read_b32 v14, a83
v_mul_f32 v14, v14, v13
v_accvgpr_write_b32 a83, v14
v_accvgpr_read_b32 v14, a84
v_mul_f32 v14, v14, v13
v_accvgpr_write_b32 a84, v14
v_accvgpr_read_b32 v14, a85
v_mul_f32 v14, v14, v13
v_accvgpr_write_b32 a85, v14
v_accvgpr_read_b32 v14, a86
v_mul_f32 v14, v14, v13
v_accvgpr_write_b32 a86, v14
v_accvgpr_read_b32 v14, a87
v_mul_f32 v14, v14, v13
v_accvgpr_write_b32 a87, v14
v_accvgpr_read_b32 v14, a88
v_mul_f32 v14, v14, v13
v_accvgpr_write_b32 a88, v14
v_accvgpr_read_b32 v14, a89
v_mul_f32 v14, v14, v13
v_accvgpr_write_b32 a89, v14
v_accvgpr_read_b32 v14, a90
v_mul_f32 v14, v14, v13
v_accvgpr_write_b32 a90, v14
v_accvgpr_read_b32 v14, a91
v_mul_f32 v14, v14, v13
v_accvgpr_write_b32 a91, v14
v_accvgpr_read_b32 v14, a92
v_mul_f32 v14, v14, v13
v_accvgpr_write_b32 a92, v14
v_accvgpr_read_b32 v14, a93
v_mul_f32 v14, v14, v13
v_accvgpr_write_b32 a93, v14
v_accvgpr_read_b32 v14, a94
v_mul_f32 v14, v14, v13
v_accvgpr_write_b32 a94, v14
v_accvgpr_read_b32 v14, a95
v_mul_f32 v14, v14, v13
v_accvgpr_write_b32 a95, v14
v_max3_f32 v12, v40, v41, v42
v_max3_f32 v12, v43, v44, v12
v_max3_f32 v12, v45, v46, v12
v_max3_f32 v12, v47, v12, 0
v_mov_b32 v13, v12
s_nop 1
v_permlane16_swap_b32 v12, v13
s_nop 1
v_max_f32 v12, v12, v13
v_mov_b32 v13, v12
s_nop 1
v_permlane32_swap_b32 v12, v13
s_nop 1
v_max_f32 v12, v12, v13
v_exp_f32 v13, -v12
v_sub_f32 v40, v40, v12
v_sub_f32 v41, v41, v12
v_sub_f32 v42, v42, v12
v_sub_f32 v43, v43, v12
v_sub_f32 v44, v44, v12
v_sub_f32 v45, v45, v12
v_sub_f32 v46, v46, v12
v_sub_f32 v47, v47, v12
v_sub_f32 v60, v60, v12
v_sub_f32 v61, v61, v12
v_sub_f32 v62, v62, v12
v_sub_f32 v63, v63, v12
v_mul_f32 v67, v67, v13
v_accvgpr_read_b32 v14, a96
v_mul_f32 v14, v14, v13
v_accvgpr_write_b32 a96, v14
v_accvgpr_read_b32 v14, a97
v_mul_f32 v14, v14, v13
v_accvgpr_write_b32 a97, v14
v_accvgpr_read_b32 v14, a98
v_mul_f32 v14, v14, v13
v_accvgpr_write_b32 a98, v14
v_accvgpr_read_b32 v14, a99
v_mul_f32 v14, v14, v13
v_accvgpr_write_b32 a99, v14
v_accvgpr_read_b32 v14, a100
v_mul_f32 v14, v14, v13
v_accvgpr_write_b32 a100, v14
v_accvgpr_read_b32 v14, a101
v_mul_f32 v14, v14, v13
v_accvgpr_write_b32 a101, v14
v_accvgpr_read_b32 v14, a102
v_mul_f32 v14, v14, v13
v_accvgpr_write_b32 a102, v14
v_accvgpr_read_b32 v14, a103
v_mul_f32 v14, v14, v13
v_accvgpr_write_b32 a103, v14
v_accvgpr_read_b32 v14, a104
v_mul_f32 v14, v14, v13
v_accvgpr_write_b32 a104, v14
v_accvgpr_read_b32 v14, a105
v_mul_f32 v14, v14, v13
v_accvgpr_write_b32 a105, v14
v_accvgpr_read_b32 v14, a106
v_mul_f32 v14, v14, v13
v_accvgpr_write_b32 a106, v14
v_accvgpr_read_b32 v14, a107
v_mul_f32 v14, v14, v13
v_accvgpr_write_b32 a107, v14
v_accvgpr_read_b32 v14, a108
v_mul_f32 v14, v14, v13
v_accvgpr_write_b32 a108, v14
v_accvgpr_read_b32 v14, a109
v_mul_f32 v14, v14, v13
v_accvgpr_write_b32 a109, v14
v_accvgpr_read_b32 v14, a110
v_mul_f32 v14, v14, v13
v_accvgpr_write_b32 a110, v14
v_accvgpr_read_b32 v14, a111
v_mul_f32 v14, v14, v13
v_accvgpr_write_b32 a111, v14
v_accvgpr_read_b32 v14, a112
v_mul_f32 v14, v14, v13
v_accvgpr_write_b32 a112, v14
v_accvgpr_read_b32 v14, a113
v_mul_f32 v14, v14, v13
v_accvgpr_write_b32 a113, v14
v_accvgpr_read_b32 v14, a114
v_mul_f32 v14, v14, v13
v_accvgpr_write_b32 a114, v14
v_accvgpr_read_b32 v14, a115
v_mul_f32 v14, v14, v13
v_accvgpr_write_b32 a115, v14
v_accvgpr_read_b32 v14, a116
v_mul_f32 v14, v14, v13
v_accvgpr_write_b32 a116, v14
v_accvgpr_read_b32 v14, a117
v_mul_f32 v14, v14, v13
v_accvgpr_write_b32 a117, v14
v_accvgpr_read_b32 v14, a118
v_mul_f32 v14, v14, v13
v_accvgpr_write_b32 a118, v14
v_accvgpr_read_b32 v14, a119
v_mul_f32 v14, v14, v13
v_accvgpr_write_b32 a119, v14
v_accvgpr_read_b32 v14, a120
v_mul_f32 v14, v14, v13
v_accvgpr_write_b32 a120, v14
v_accvgpr_read_b32 v14, a121
v_mul_f32 v14, v14, v13
v_accvgpr_write_b32 a121, v14
v_accvgpr_read_b32 v14, a122
v_mul_f32 v14, v14, v13
v_accvgpr_write_b32 a122, v14
v_accvgpr_read_b32 v14, a123
v_mul_f32 v14, v14, v13
v_accvgpr_write_b32 a123, v14
v_accvgpr_read_b32 v14, a124
v_mul_f32 v14, v14, v13
v_accvgpr_write_b32 a124, v14
v_accvgpr_read_b32 v14, a125
v_mul_f32 v14, v14, v13
v_accvgpr_write_b32 a125, v14
v_accvgpr_read_b32 v14, a126
v_mul_f32 v14, v14, v13
v_accvgpr_write_b32 a126, v14
v_accvgpr_read_b32 v14, a127
v_mul_f32 v14, v14, v13
v_accvgpr_write_b32 a127, v14
v_exp_f32 v96, v32
v_exp_f32 v97, v33
v_exp_f32 v98, v34
v_exp_f32 v99, v35
v_exp_f32 v100, v36
v_exp_f32 v101, v37
v_exp_f32 v102, v38
v_exp_f32 v103, v39
v_exp_f32 v104, v40
v_exp_f32 v105, v41
v_exp_f32 v106, v42
v_exp_f32 v107, v43
v_exp_f32 v108, v44
v_exp_f32 v109, v45
v_exp_f32 v110, v46
v_exp_f32 v111, v47
s_nop 0
v_add_f32 v10, v96, v97
v_add_f32 v10, v10, v98
v_add_f32 v10, v10, v99
v_add_f32 v10, v10, v100
v_add_f32 v10, v10, v101
v_add_f32 v10, v10, v102
v_add_f32 v10, v10, v103
v_add_f32 v11, v104, v105
v_add_f32 v11, v11, v106
v_add_f32 v11, v11, v107
v_add_f32 v11, v11, v108
v_add_f32 v11, v11, v109
v_add_f32 v11, v11, v110
v_add_f32 v11, v11, v111
v_cvt_pk_bf16_f32 v120, v96, v97
v_cvt_pk_bf16_f32 v121, v98, v99
v_cvt_pk_bf16_f32 v122, v100, v101
v_cvt_pk_bf16_f32 v123, v102, v103
v_cvt_pk_bf16_f32 v124, v104, v105
v_cvt_pk_bf16_f32 v125, v106, v107
v_cvt_pk_bf16_f32 v126, v108, v109
v_cvt_pk_bf16_f32 v127, v110, v111
s_nop 3
s_setpc_b64 s[66:67]
.section .rodata,"a"
.p2align 6
.amdhsa_kernel standalone__kv_cache_quant_pre_rope_vs_post_rope__prompt_kernel
  .amdhsa_next_free_vgpr 512
  .amdhsa_next_free_sgpr 102
  .amdhsa_accum_offset 256
  .amdhsa_group_segment_fixed_size 0
  .amdhsa_kernarg_size 112
  .amdhsa_user_sgpr_count 2
  .amdhsa_user_sgpr_kernarg_segment_ptr 1
  .amdhsa_system_sgpr_workgroup_id_x 1
.end_amdhsa_kernel
```
